```python
import torch

def _softmax(x, axis=-1):
    return torch.softmax(x, dim=axis)

def _gelu(x):
    return torch.nn.functional.gelu(x, approximate='tanh')

def _silu(x):
    return torch.nn.functional.silu(x)

def _sigmoid(x):
    return torch.sigmoid(x)

def _layernorm(x, axis=-1, eps=1e-05):
    m = x.mean(dim=axis, keepdim=True)
    v = x.var(dim=axis, keepdim=True, unbiased=False)
    return (x - m) / torch.sqrt(v + eps)

def _scatter_add(tgt, idx, src, axis=0):
    return tgt.clone().index_add_(axis, idx, src)

def _segment_sum(src, seg, n):
    out = torch.zeros((n,) + src.shape[1:], dtype=src.dtype)
    return out.index_add_(0, seg, src)

def _pad(x, pw):
    flat = tuple((v for pair in reversed(pw) for v in pair))
    return torch.nn.functional.pad(x, flat)
kernel_name = 'adaLN_cond__gqa_block_cached__geglu_ffn__decode'

def setup_inputs():

    _w = lambda a: (lambda t: t.to(torch.bfloat16) if t.is_floating_point() else t)(torch.as_tensor(a))

    def _A_setup():
        B, Sq, D = (4, 1, 1024)
        Hq, Hkv, Sk, Dh = (32, 4, 16384, 128)
        assert Hq % Hkv == 0, (Hq, Hkv)
        return {'x': _w((lambda *s: torch.randn(*s, dtype=torch.bfloat16) * 0.1)(B, Sq, D)), 'k_cache': _w((lambda *s: torch.randn(*s, dtype=torch.bfloat16) * 0.8)(B, Hkv, Sk, Dh)), 'v_cache': _w((lambda *s: torch.randn(*s, dtype=torch.bfloat16) * 0.8)(B, Hkv, Sk, Dh)), 'wq': _w((lambda *s: torch.randn(*s, dtype=torch.bfloat16) * 0.8)(D, Hq * Dh) * D ** (-0.5)), 'wo': _w((lambda *s: torch.randn(*s, dtype=torch.bfloat16) * 0.8)(Hq * Dh, D) * (Hq * Dh) ** (-0.5))}
    _A_in = _A_setup()

    def _B_setup():
        B, S, D, F = (4, 1, 1024, 3584)
        return {'x': _w((lambda *s: torch.randn(*s, dtype=torch.bfloat16) * 0.1)(B, S, D)), 'w_gate': _w((lambda *s: torch.randn(*s, dtype=torch.bfloat16) * 0.1)(D, F)), 'w_up': _w((lambda *s: torch.randn(*s, dtype=torch.bfloat16) * 0.1)(D, F)), 'w_down': _w((lambda *s: torch.randn(*s, dtype=torch.bfloat16) * 0.1)(F, D))}
    _B_in = _B_setup()
    return {'A_x': _A_in['x'], 'A_k_cache': _A_in['k_cache'], 'A_v_cache': _A_in['v_cache'], 'A_wq': _A_in['wq'], 'A_wo': _A_in['wo'], 'B_x': _B_in['x'], 'B_w_gate': _B_in['w_gate'], 'B_w_up': _B_in['w_up'], 'B_w_down': _B_in['w_down'], 'c': _w((lambda *s: torch.randn(*s, dtype=torch.bfloat16) * 0.4)(4, 1024) * 8.0), 'w_mod': _w((lambda *s: torch.randn(*s, dtype=torch.bfloat16) * 0.4)(1024, 6 * 1024) * 1024 ** (-0.5) * 8.0)}

def reference(A_x, A_k_cache, A_v_cache, A_wq, A_wo, B_x, B_w_gate, B_w_up, B_w_down, c, w_mod):

    def _A_ref(x, k_cache, v_cache, wq, wo):
        B, Sq, D = x.shape
        Hq, Dh = (32, 128)
        Hkv = k_cache.shape[1]
        rep = Hq // Hkv
        q = (lambda x, *d: x.permute(*d))((x @ wq).reshape(B, Sq, Hq, Dh), 0, 2, 1, 3)
        k = (lambda x, n, axis: torch.repeat_interleave(x, n, dim=axis))(k_cache, rep, axis=1)
        v = (lambda x, n, axis: torch.repeat_interleave(x, n, dim=axis))(v_cache, rep, axis=1)
        scores = torch.einsum('bhqd,bhkd->bhqk', q, k) * Dh ** (-0.5)
        p = _softmax(scores, axis=-1)
        o = torch.einsum('bhqk,bhkd->bhqd', p, v)
        return (lambda x, *d: x.permute(*d))(o, 0, 2, 1, 3).reshape(B, Sq, Hq * Dh) @ wo

    def _B_ref(x, w_gate, w_up, w_down):
        return _gelu(x @ w_gate) * (x @ w_up) @ w_down
    x = A_x
    mod = (_silu(c) @ w_mod).reshape(c.shape[0], 6, 1, -1)
    sa, ca, ga, sb, cb, gb = (mod[:, 0].clone(), mod[:, 1].clone(), mod[:, 2].clone(), mod[:, 3].clone(), mod[:, 4].clone(), mod[:, 5].clone())
    h = _layernorm(x, axis=-1) * (1 + ca) + sa
    x = x + ga * _A_ref(h, A_k_cache, A_v_cache, A_wq, A_wo)
    h = _layernorm(x, axis=-1) * (1 + cb) + sb
    x = x + gb * _B_ref(h, B_w_gate, B_w_up, B_w_down)
    return x
```

```asm
; @launch grid=(256,1,1) block=(512,1,1) lds=159616
.amdgcn_target "amdgcn-amd-amdhsa--gfx950"
.text
.p2align 12
.globl adaLN_cond__gqa_block_cached__geglu_ffn__decode_kernel
.p2align 8
.type adaLN_cond__gqa_block_cached__geglu_ffn__decode_kernel,@function
adaLN_cond__gqa_block_cached__geglu_ffn__decode_kernel:
    s_cmpk_ge_u32 s2, 256
    s_cbranch_scc1 L_end
    s_load_dwordx16 s[36:51], s[0:1], 0
    s_load_dwordx8 s[52:59], s[0:1], 64
    s_load_dwordx4 s[60:63], s[0:1], 96
    v_lshrrev_b32 v1, 6, v0
    v_and_b32 v0, 63, v0
    v_readfirstlane_b32 s3, v1
    v_and_b32 v1, 15, v0
    v_lshrrev_b32 v2, 4, v0
    v_lshlrev_b32 v3, 4, v0
    s_cmpk_lt_u32 s2, 96
    s_cselect_b32 s22, 12, 8
    s_cselect_b32 s23, 0, 96
    s_lshl_b32 s22, s22, 10
    s_sub_u32 s23, s2, s23
    s_lshl_b32 s23, s23, 7
    s_cmp_ge_u32 s3, 4
    s_cbranch_scc1 L_gemv
    s_cmpk_lt_u32 s2, 160
    s_cbranch_scc1 L_tmq
    v_lshlrev_b32 v14, 14, v2
    s_mov_b32 s34, 8
    v_lshlrev_b32 v12, 1, v2
    v_xor_b32 v12, v12, v1
    v_xor_b32 v13, s34, v12
    v_lshl_add_u32 v12, v12, 4, v14
    v_lshl_add_u32 v13, v13, 4, v14
    s_cmpk_ge_u32 s2, 224
    s_cselect_b32 s26, 1, 0
    s_cselect_b32 s27, 24, 20
    s_cselect_b32 s29, 0, 4
    s_lshr_b32 s28, s2, 3
    s_sub_u32 s28, s28, s27
    s_lshl2_add_u32 s28, s28, s3
    s_lshl_b32 s28, s28, s26
    s_lshl_b32 s28, s28, 9
    s_and_b32 s35, s2, 7
    s_add_u32 s28, s28, s35
    s_lshl_b32 s28, s28, 8
    s_add_u32 s29, s29, s3
    s_lshl_b32 s29, s29, 14
    s_lshl_b32 s29, s29, s26
    s_movk_i32 s24, 2048
    s_mul_i32 s25, s24, 25
    s_movk_i32 s30, 1024
    s_waitcnt lgkmcnt(0)
    s_mov_b32 s16, s44
    s_mov_b32 s17, s45
    s_branch L_tile
L_tmq:
    s_lshl_b32 s24, s22, 7
    s_lshl_b32 s25, s3, 1
    v_lshrrev_b32 v12, 3, v0
    v_mul_lo_u32 v14, v12, s24
    v_and_b32 v13, 7, v0
    v_xor_b32 v12, s25, v13
    v_lshl_add_u32 v12, v12, 4, v14
    v_mov_b32 v13, v12
    s_mul_i32 s28, s22, s3
    s_add_u32 s28, s28, s23
    s_lshl_b32 s24, s22, 2
    s_mov_b32 s25, s24
    s_lshl_b32 s29, s3, 10
    s_movk_i32 s30, 4096
    s_waitcnt lgkmcnt(0)
    s_cmpk_lt_u32 s2, 96
    s_cselect_b32 s16, s56, s42
    s_cselect_b32 s17, s57, s43
L_tile:
    s_lshl_b32 s18, s22, 10
    s_mov_b32 s19, 0x20000
    s_mov_b32 m0, s29
    s_add_u32 s29, s29, s30
    buffer_load_dwordx4 v12, s[16:19], s28 offen nt lds
    s_add_u32 s28, s28, s24
    s_mov_b32 m0, s29
    s_add_u32 s29, s29, s30
    buffer_load_dwordx4 v13, s[16:19], s28 offen nt lds
    s_add_u32 s28, s28, s24
    s_mov_b32 m0, s29
    s_add_u32 s29, s29, s30
    buffer_load_dwordx4 v12, s[16:19], s28 offen nt lds
    s_add_u32 s28, s28, s24
    s_mov_b32 m0, s29
    s_add_u32 s29, s29, s30
    buffer_load_dwordx4 v13, s[16:19], s28 offen nt lds
    s_add_u32 s28, s28, s24
    s_mov_b32 m0, s29
    s_add_u32 s29, s29, s30
    buffer_load_dwordx4 v12, s[16:19], s28 offen nt lds
    s_add_u32 s28, s28, s24
    s_lshl_b32 s34, s3, 2
    s_add_u32 s34, s34, 142992
    v_mov_b32 v15, s34
    s_barrier
    s_mov_b32 m0, s29
    s_add_u32 s29, s29, s30
    s_waitcnt vmcnt(4)
    buffer_load_dwordx4 v13, s[16:19], s28 offen nt lds
    s_add_u32 s28, s28, s24
    s_mov_b32 m0, s29
    s_add_u32 s29, s29, s30
    s_waitcnt vmcnt(4)
    buffer_load_dwordx4 v12, s[16:19], s28 offen nt lds
    s_add_u32 s28, s28, s24
    s_mov_b32 m0, s29
    s_add_u32 s29, s29, s30
    s_waitcnt vmcnt(4)
    buffer_load_dwordx4 v13, s[16:19], s28 offen nt lds
    s_add_u32 s28, s28, s25
    s_mov_b32 m0, s29
    s_add_u32 s29, s29, s30
    s_waitcnt vmcnt(4)
    buffer_load_dwordx4 v12, s[16:19], s28 offen nt lds
    s_add_u32 s28, s28, s24
    s_mov_b32 m0, s29
    s_add_u32 s29, s29, s30
    s_waitcnt vmcnt(4)
    buffer_load_dwordx4 v13, s[16:19], s28 offen nt lds
    s_add_u32 s28, s28, s24
    s_mov_b32 m0, s29
    s_add_u32 s29, s29, s30
    s_waitcnt vmcnt(4)
    buffer_load_dwordx4 v12, s[16:19], s28 offen nt lds
    s_add_u32 s28, s28, s24
    s_mov_b32 m0, s29
    s_add_u32 s29, s29, s30
    s_waitcnt vmcnt(4)
    buffer_load_dwordx4 v13, s[16:19], s28 offen nt lds
    s_add_u32 s28, s28, s24
    s_mov_b32 m0, s29
    s_add_u32 s29, s29, s30
    s_waitcnt vmcnt(4)
    buffer_load_dwordx4 v12, s[16:19], s28 offen nt lds
    s_add_u32 s28, s28, s24
    v_mov_b32 v14, 1
    ds_write_b32 v15, v14
    s_mov_b32 m0, s29
    s_add_u32 s29, s29, s30
    s_waitcnt vmcnt(4)
    buffer_load_dwordx4 v13, s[16:19], s28 offen nt lds
    s_add_u32 s28, s28, s24
    s_mov_b32 m0, s29
    s_add_u32 s29, s29, s30
    s_waitcnt vmcnt(4)
    buffer_load_dwordx4 v12, s[16:19], s28 offen nt lds
    s_add_u32 s28, s28, s24
    s_mov_b32 m0, s29
    s_add_u32 s29, s29, s30
    s_waitcnt vmcnt(4)
    buffer_load_dwordx4 v13, s[16:19], s28 offen nt lds
    s_add_u32 s28, s28, s25
    s_sub_u32 s34, s2, 160
    s_cmp_ge_u32 s34, 64
    s_cbranch_scc1 L_tile2
    s_bitcmp0_b32 s2, 0
    s_cselect_b32 s16, s48, s50
    s_cselect_b32 s17, s49, s51
    s_mov_b32 s18, 7340032
    s_mov_b32 s19, 0x20000
    v_mul_u32_u24 v14, 7168, v2
    s_mov_b32 s34, 8
    v_lshlrev_b32 v12, 1, v2
    v_xor_b32 v12, v12, v1
    v_xor_b32 v13, s34, v12
    v_lshl_add_u32 v12, v12, 4, v14
    v_lshl_add_u32 v13, v13, 4, v14
    s_lshr_b32 s35, s2, 3
    s_add_u32 s28, s35, 2
    s_mul_i32 s28, s28, 43
    s_lshr_b32 s28, s28, 7
    s_add_u32 s28, s28, s35
    s_lshl_b32 s35, s35, 2
    s_sub_u32 s35, s35, 79
    s_min_u32 s35, s35, 27
    s_cmp_lt_u32 s2, 160
    s_cselect_b32 s35, s28, s35
    s_bfe_u32 s28, s2, 131073
    s_lshl_b32 s28, s28, 2
    s_add_u32 s28, s28, s3
    s_mul_i32 s28, s28, 458752
    s_lshl_b32 s35, s35, 8
    s_add_u32 s28, s28, s35
    s_lshl_b32 s29, s3, 14
    s_add_u32 s29, s29, 0
    s_movk_i32 s24, 28672
    s_mov_b32 s25, s24
L_tile2:
    s_mov_b32 m0, s29
    s_add_u32 s29, s29, s30
    s_waitcnt vmcnt(4)
    buffer_load_dwordx4 v12, s[16:19], s28 offen nt lds
    s_add_u32 s28, s28, s24
    s_mov_b32 m0, s29
    s_add_u32 s29, s29, s30
    s_waitcnt vmcnt(4)
    buffer_load_dwordx4 v13, s[16:19], s28 offen nt lds
    s_add_u32 s28, s28, s24
    s_mov_b32 m0, s29
    s_add_u32 s29, s29, s30
    s_waitcnt vmcnt(4)
    buffer_load_dwordx4 v12, s[16:19], s28 offen nt lds
    s_add_u32 s28, s28, s24
    s_mov_b32 m0, s29
    s_add_u32 s29, s29, s30
    s_waitcnt vmcnt(4)
    buffer_load_dwordx4 v13, s[16:19], s28 offen nt lds
    s_add_u32 s28, s28, s24
    s_mov_b32 m0, s29
    s_add_u32 s29, s29, s30
    s_waitcnt vmcnt(4)
    buffer_load_dwordx4 v12, s[16:19], s28 offen nt lds
    s_add_u32 s28, s28, s24
    v_mov_b32 v14, 2
    ds_write_b32 v15, v14
    s_mov_b32 m0, s29
    s_add_u32 s29, s29, s30
    s_waitcnt vmcnt(4)
    buffer_load_dwordx4 v13, s[16:19], s28 offen nt lds
    s_add_u32 s28, s28, s24
    s_mov_b32 m0, s29
    s_add_u32 s29, s29, s30
    s_waitcnt vmcnt(4)
    buffer_load_dwordx4 v12, s[16:19], s28 offen nt lds
    s_add_u32 s28, s28, s24
    s_mov_b32 m0, s29
    s_add_u32 s29, s29, s30
    s_waitcnt vmcnt(4)
    buffer_load_dwordx4 v13, s[16:19], s28 offen nt lds
    s_add_u32 s28, s28, s25
    s_mov_b32 m0, s29
    s_add_u32 s29, s29, s30
    s_waitcnt vmcnt(4)
    buffer_load_dwordx4 v12, s[16:19], s28 offen nt lds
    s_add_u32 s28, s28, s24
    s_mov_b32 m0, s29
    s_add_u32 s29, s29, s30
    s_waitcnt vmcnt(4)
    buffer_load_dwordx4 v13, s[16:19], s28 offen nt lds
    s_add_u32 s28, s28, s24
    s_mov_b32 m0, s29
    s_add_u32 s29, s29, s30
    s_waitcnt vmcnt(4)
    buffer_load_dwordx4 v12, s[16:19], s28 offen nt lds
    s_add_u32 s28, s28, s24
    s_mov_b32 m0, s29
    s_add_u32 s29, s29, s30
    s_waitcnt vmcnt(4)
    buffer_load_dwordx4 v13, s[16:19], s28 offen nt lds
    s_add_u32 s28, s28, s24
    s_mov_b32 m0, s29
    s_add_u32 s29, s29, s30
    s_waitcnt vmcnt(4)
    buffer_load_dwordx4 v12, s[16:19], s28 offen nt lds
    s_add_u32 s28, s28, s24
    v_mov_b32 v14, 3
    ds_write_b32 v15, v14
    s_mov_b32 m0, s29
    s_add_u32 s29, s29, s30
    s_waitcnt vmcnt(4)
    buffer_load_dwordx4 v13, s[16:19], s28 offen nt lds
    s_add_u32 s28, s28, s24
    s_mov_b32 m0, s29
    s_add_u32 s29, s29, s30
    s_waitcnt vmcnt(4)
    buffer_load_dwordx4 v12, s[16:19], s28 offen nt lds
    s_add_u32 s28, s28, s24
    s_mov_b32 m0, s29
    s_add_u32 s29, s29, s30
    s_waitcnt vmcnt(4)
    buffer_load_dwordx4 v13, s[16:19], s28 offen nt lds
    s_add_u32 s28, s28, s25
    s_and_b32 s69, s2, 7
    s_lshl_b32 s69, s69, 1
    s_bfe_u32 s68, s2, 0x10003
    s_add_u32 s69, s69, s68
    s_lshl_b32 s69, s69, 4
    s_lshr_b32 s68, s2, 4
    s_add_u32 s69, s69, s68
    s_mov_b32 s12, s62
    s_mov_b32 s13, s63
    s_mov_b32 s14, 1376256
    s_mov_b32 s15, 0x20000
    v_bfe_u32 v4, v1, 1, 1
    v_lshlrev_b32 v4, 2, v4
    v_lshrrev_b32 v6, 2, v1
    v_add_u32 v4, v4, v6
    v_lshlrev_b32 v4, 8, v4
    v_lshl_add_u32 v4, v2, 5, v4
    v_and_b32 v6, 1, v1
    v_lshl_add_u32 v4, v6, 4, v4
    s_lshl_b32 s20, s69, 18
    s_lshl_b32 s21, s3, 12
    s_add_u32 s20, s20, s21
    s_mov_b32 s21, s20
    s_mov_b32 s4, s38
    s_mov_b32 s5, s39
    s_mov_b32 s6, 67108864
    s_mov_b32 s7, 0x20000
    s_mov_b32 s8, s40
    s_mov_b32 s9, s41
    s_mov_b32 s10, 67108864
    s_mov_b32 s11, 0x20000
    s_waitcnt vmcnt(4)
    buffer_load_dwordx4 v[32:35], v4, s[4:7], s20 offen offset:0 nt
    s_waitcnt vmcnt(4)
    buffer_load_dwordx4 v[36:39], v4, s[4:7], s20 offen offset:128 nt
    s_waitcnt vmcnt(4)
    buffer_load_dwordx4 v[40:43], v4, s[4:7], s20 offen offset:2048 nt
    s_waitcnt vmcnt(4)
    buffer_load_dwordx4 v[44:47], v4, s[4:7], s20 offen offset:2176 nt
    s_add_u32 s20, s20, 16384
    s_waitcnt vmcnt(4)
    buffer_load_dwordx4 v[48:51], v4, s[4:7], s20 offen offset:0 nt
    v_mov_b32 v14, 4
    ds_write_b32 v15, v14
    s_waitcnt vmcnt(4)
    buffer_load_dwordx4 v[52:55], v4, s[4:7], s20 offen offset:128 nt
    s_waitcnt vmcnt(4)
    buffer_load_dwordx4 v[56:59], v4, s[4:7], s20 offen offset:2048 nt
    s_waitcnt vmcnt(4)
    buffer_load_dwordx4 v[60:63], v4, s[4:7], s20 offen offset:2176 nt
    s_add_u32 s20, s20, 16384
    v_mov_b32 v14, 5
    ds_write_b32 v15, v14
    s_mov_b64 vcc, 0
    s_mov_b32 s66, 0
    s_waitcnt vmcnt(4)
    buffer_load_dwordx4 v[64:67], v4, s[4:7], s20 offen offset:0 nt
    s_waitcnt vmcnt(4)
    buffer_load_dwordx4 v[68:71], v4, s[4:7], s20 offen offset:128 nt
    v_mov_b32 v9, 143024
    ds_read_b32 v9, v9
    s_waitcnt vmcnt(4)
    buffer_load_dwordx4 v[72:75], v4, s[4:7], s20 offen offset:2048 nt
    s_waitcnt lgkmcnt(0)
    v_cmp_eq_u32 vcc, 1, v9
    s_cbranch_vccnz Lw_1
    s_waitcnt vmcnt(4)
Lw_1:
    buffer_load_dwordx4 v[76:79], v4, s[4:7], s20 offen offset:2176 nt
    s_add_u32 s20, s20, 16384
    s_cbranch_vccnz Lw_2
    s_waitcnt vmcnt(4)
Lw_2:
    buffer_load_dwordx4 v[80:83], v4, s[4:7], s20 offen offset:0 nt
    v_mov_b32 v9, 143024
    ds_read_b32 v9, v9
    s_cbranch_vccnz Lw_3
    s_waitcnt vmcnt(4)
Lw_3:
    buffer_load_dwordx4 v[84:87], v4, s[4:7], s20 offen offset:128 nt
    s_waitcnt lgkmcnt(0)
    v_cmp_eq_u32 vcc, 1, v9
    s_waitcnt vmcnt(7)
    s_cbranch_vccnz Lw_4
    s_waitcnt vmcnt(4)
Lw_4:
    buffer_load_dwordx4 v[88:91], v4, s[4:7], s20 offen offset:2048 nt
    s_waitcnt vmcnt(7)
    s_cbranch_vccnz Lw_5
    s_waitcnt vmcnt(4)
Lw_5:
    buffer_load_dwordx4 v[92:95], v4, s[4:7], s20 offen offset:2176 nt
    s_add_u32 s20, s20, 16384
    v_mov_b32 v9, 143024
    ds_read_b32 v9, v9
    s_waitcnt vmcnt(7)
    s_cbranch_vccnz Lw_6
    s_waitcnt vmcnt(4)
Lw_6:
    buffer_load_dwordx4 v[96:99], v4, s[4:7], s20 offen offset:0 nt
    s_waitcnt lgkmcnt(0)
    v_cmp_eq_u32 vcc, 1, v9
    s_waitcnt vmcnt(7)
    s_cbranch_vccnz Lw_7
    s_waitcnt vmcnt(4)
Lw_7:
    buffer_load_dwordx4 v[100:103], v4, s[4:7], s20 offen offset:128 nt
    s_waitcnt vmcnt(7)
    s_cbranch_vccnz Lw_8
    s_waitcnt vmcnt(4)
Lw_8:
    buffer_load_dwordx4 v[104:107], v4, s[4:7], s20 offen offset:2048 nt
    v_mov_b32 v9, 143024
    ds_read_b32 v9, v9
    s_waitcnt vmcnt(7)
    s_cbranch_vccnz Lw_9
    s_waitcnt vmcnt(4)
Lw_9:
    buffer_load_dwordx4 v[108:111], v4, s[4:7], s20 offen offset:2176 nt
    s_add_u32 s20, s20, 16384
    s_waitcnt lgkmcnt(0)
    v_cmp_eq_u32 vcc, 1, v9
    s_waitcnt vmcnt(7)
    s_cbranch_vccnz Lw_10
    s_waitcnt vmcnt(4)
Lw_10:
    buffer_load_dwordx4 v[112:115], v4, s[4:7], s20 offen offset:0 nt
    v_mov_b32 v14, 6
    ds_write_b32 v15, v14
    s_waitcnt vmcnt(7)
    s_cbranch_vccnz Lw_11
    s_waitcnt vmcnt(4)
Lw_11:
    buffer_load_dwordx4 v[116:119], v4, s[4:7], s20 offen offset:128 nt
    v_mov_b32 v9, 143024
    ds_read_b32 v9, v9
    s_waitcnt vmcnt(7)
    s_cbranch_vccnz Lw_12
    s_waitcnt vmcnt(4)
Lw_12:
    buffer_load_dwordx4 v[120:123], v4, s[4:7], s20 offen offset:2048 nt
    s_waitcnt lgkmcnt(0)
    v_cmp_eq_u32 vcc, 1, v9
    s_waitcnt vmcnt(7)
    s_cbranch_vccnz Lw_13
    s_waitcnt vmcnt(4)
Lw_13:
    buffer_load_dwordx4 v[124:127], v4, s[4:7], s20 offen offset:2176 nt
    s_add_u32 s20, s20, 16384
    s_waitcnt vmcnt(7)
    s_cbranch_vccnz Lw_14
    s_waitcnt vmcnt(4)
Lw_14:
    buffer_load_dwordx4 v[128:131], v4, s[4:7], s20 offen offset:0 nt
    v_mov_b32 v9, 143024
    ds_read_b32 v9, v9
    s_waitcnt vmcnt(7)
    s_cbranch_vccnz Lw_15
    s_waitcnt vmcnt(4)
Lw_15:
    buffer_load_dwordx4 v[132:135], v4, s[4:7], s20 offen offset:128 nt
    s_waitcnt lgkmcnt(0)
    v_cmp_eq_u32 vcc, 1, v9
    s_waitcnt vmcnt(7)
    s_cbranch_vccnz Lw_16
    s_waitcnt vmcnt(4)
Lw_16:
    buffer_load_dwordx4 v[136:139], v4, s[4:7], s20 offen offset:2048 nt
    v_mov_b32 v14, 7
    ds_write_b32 v15, v14
    s_waitcnt vmcnt(7)
    s_cbranch_vccnz Lw_17
    s_waitcnt vmcnt(4)
Lw_17:
    buffer_load_dwordx4 v[140:143], v4, s[4:7], s20 offen offset:2176 nt
    s_add_u32 s20, s20, 16384
    v_mov_b32 v9, 143024
    ds_read_b32 v9, v9
    s_waitcnt vmcnt(7)
    s_cbranch_vccnz Lw_18
    s_waitcnt vmcnt(4)
Lw_18:
    buffer_load_dwordx4 v[144:147], v4, s[4:7], s20 offen offset:0 nt
    s_waitcnt lgkmcnt(0)
    v_cmp_eq_u32 vcc, 1, v9
    s_waitcnt vmcnt(7)
    s_cbranch_vccnz Lw_19
    s_waitcnt vmcnt(4)
Lw_19:
    buffer_load_dwordx4 v[148:151], v4, s[4:7], s20 offen offset:128 nt
    s_waitcnt vmcnt(7)
    s_cbranch_vccnz Lw_20
    s_waitcnt vmcnt(4)
Lw_20:
    buffer_load_dwordx4 v[152:155], v4, s[4:7], s20 offen offset:2048 nt
    v_mov_b32 v9, 143024
    ds_read_b32 v9, v9
    s_waitcnt vmcnt(7)
    s_cbranch_vccnz Lw_21
    s_waitcnt vmcnt(4)
Lw_21:
    buffer_load_dwordx4 v[156:159], v4, s[4:7], s20 offen offset:2176 nt
    s_add_u32 s20, s20, 16384
    s_waitcnt lgkmcnt(0)
    v_cmp_eq_u32 vcc, 1, v9
    s_waitcnt vmcnt(7)
    s_cbranch_vccnz Lw_22
    s_waitcnt vmcnt(4)
Lw_22:
    buffer_load_dwordx4 v[160:163], v4, s[4:7], s20 offen offset:0 nt
    s_waitcnt vmcnt(7)
    s_cbranch_vccnz Lw_23
    s_waitcnt vmcnt(4)
Lw_23:
    buffer_load_dwordx4 v[164:167], v4, s[4:7], s20 offen offset:128 nt
    v_mov_b32 v9, 143024
    ds_read_b32 v9, v9
    s_waitcnt vmcnt(7)
    s_cbranch_vccnz Lw_24
    s_waitcnt vmcnt(4)
Lw_24:
    buffer_load_dwordx4 v[168:171], v4, s[4:7], s20 offen offset:2048 nt
    s_waitcnt lgkmcnt(0)
    v_cmp_eq_u32 vcc, 1, v9
    s_waitcnt vmcnt(7)
    s_cbranch_vccnz Lw_25
    s_waitcnt vmcnt(4)
Lw_25:
    buffer_load_dwordx4 v[172:175], v4, s[4:7], s20 offen offset:2176 nt
    s_add_u32 s20, s20, 16384
    s_waitcnt vmcnt(7)
    s_cbranch_vccnz Lw_26
    s_waitcnt vmcnt(4)
Lw_26:
    buffer_load_dwordx4 v[176:179], v4, s[4:7], s20 offen offset:0 nt
    v_mov_b32 v9, 143024
    ds_read_b32 v9, v9
    s_waitcnt vmcnt(7)
    s_cbranch_vccnz Lw_27
    s_waitcnt vmcnt(4)
Lw_27:
    buffer_load_dwordx4 v[180:183], v4, s[4:7], s20 offen offset:128 nt
    s_waitcnt lgkmcnt(0)
    v_cmp_eq_u32 vcc, 1, v9
    s_waitcnt vmcnt(7)
    s_cbranch_vccnz Lw_28
    s_waitcnt vmcnt(4)
Lw_28:
    buffer_load_dwordx4 v[184:187], v4, s[4:7], s20 offen offset:2048 nt
    s_waitcnt vmcnt(7)
    s_cbranch_vccnz Lw_29
    s_waitcnt vmcnt(4)
Lw_29:
    buffer_load_dwordx4 v[188:191], v4, s[4:7], s20 offen offset:2176 nt
    s_add_u32 s20, s20, 16384
    v_mov_b32 v9, 143024
    ds_read_b32 v9, v9
    s_waitcnt vmcnt(7)
    s_cbranch_vccnz Lw_30
    s_waitcnt vmcnt(4)
Lw_30:
    buffer_load_dwordx4 v[192:195], v4, s[4:7], s20 offen offset:0 nt
    v_mov_b32 v14, 8
    ds_write_b32 v15, v14
    s_waitcnt lgkmcnt(0)
    v_cmp_eq_u32 vcc, 1, v9
    s_waitcnt vmcnt(7)
    s_cbranch_vccnz Lw_31
    s_waitcnt vmcnt(4)
Lw_31:
    buffer_load_dwordx4 v[196:199], v4, s[4:7], s20 offen offset:128 nt
    s_waitcnt vmcnt(7)
    s_cbranch_vccnz Lw_32
    s_waitcnt vmcnt(4)
Lw_32:
    buffer_load_dwordx4 v[200:203], v4, s[4:7], s20 offen offset:2048 nt
    v_mov_b32 v9, 143024
    ds_read_b32 v9, v9
    s_waitcnt vmcnt(7)
    s_cbranch_vccnz Lw_33
    s_waitcnt vmcnt(4)
Lw_33:
    buffer_load_dwordx4 v[204:207], v4, s[4:7], s20 offen offset:2176 nt
    s_add_u32 s20, s20, 16384
    s_waitcnt lgkmcnt(0)
    v_cmp_eq_u32 vcc, 1, v9
    s_waitcnt vmcnt(7)
    s_cbranch_vccnz Lw_34
    s_waitcnt vmcnt(4)
Lw_34:
    buffer_load_dwordx4 v[208:211], v4, s[4:7], s20 offen offset:0 nt
    s_waitcnt vmcnt(7)
    s_cbranch_vccnz Lw_35
    s_waitcnt vmcnt(4)
Lw_35:
    buffer_load_dwordx4 v[212:215], v4, s[4:7], s20 offen offset:128 nt
    v_mov_b32 v9, 143024
    ds_read_b32 v9, v9
    s_waitcnt vmcnt(7)
    s_cbranch_vccnz Lw_36
    s_waitcnt vmcnt(4)
Lw_36:
    buffer_load_dwordx4 v[216:219], v4, s[4:7], s20 offen offset:2048 nt
    s_waitcnt lgkmcnt(0)
    v_cmp_eq_u32 vcc, 1, v9
    s_waitcnt vmcnt(7)
    s_cbranch_vccnz Lw_37
    s_waitcnt vmcnt(4)
Lw_37:
    buffer_load_dwordx4 v[220:223], v4, s[4:7], s20 offen offset:2176 nt
    s_add_u32 s20, s20, 16384
    s_waitcnt vmcnt(7)
    s_cbranch_vccnz Lw_38
    s_waitcnt vmcnt(4)
Lw_38:
    buffer_load_dwordx4 v[224:227], v4, s[4:7], s20 offen offset:0 nt
    v_mov_b32 v9, 143024
    ds_read_b32 v9, v9
    s_waitcnt vmcnt(7)
    s_cbranch_vccnz Lw_39
    s_waitcnt vmcnt(4)
Lw_39:
    buffer_load_dwordx4 v[228:231], v4, s[4:7], s20 offen offset:128 nt
    s_waitcnt lgkmcnt(0)
    v_cmp_eq_u32 vcc, 1, v9
    s_waitcnt vmcnt(7)
    s_cbranch_vccnz Lw_40
    s_waitcnt vmcnt(4)
Lw_40:
    buffer_load_dwordx4 v[232:235], v4, s[4:7], s20 offen offset:2048 nt
    s_waitcnt vmcnt(7)
    s_cbranch_vccnz Lw_41
    s_waitcnt vmcnt(4)
Lw_41:
    buffer_load_dwordx4 v[236:239], v4, s[4:7], s20 offen offset:2176 nt
    s_add_u32 s20, s20, 16384
    v_mov_b32 v9, 143024
    ds_read_b32 v9, v9
    s_waitcnt vmcnt(7)
    s_cbranch_vccnz Lw_42
    s_waitcnt vmcnt(4)
Lw_42:
    buffer_load_dwordx4 v[240:243], v4, s[4:7], s20 offen offset:0 nt
    s_waitcnt lgkmcnt(0)
    v_cmp_eq_u32 vcc, 1, v9
    s_waitcnt vmcnt(7)
    s_cbranch_vccnz Lw_43
    s_waitcnt vmcnt(4)
Lw_43:
    buffer_load_dwordx4 v[244:247], v4, s[4:7], s20 offen offset:128 nt
    s_waitcnt vmcnt(7)
    s_cbranch_vccnz Lw_44
    s_waitcnt vmcnt(4)
Lw_44:
    buffer_load_dwordx4 v[248:251], v4, s[4:7], s20 offen offset:2048 nt
    v_mov_b32 v14, 9
    ds_write_b32 v15, v14
    v_mov_b32 v9, 143024
    ds_read_b32 v9, v9
    s_waitcnt vmcnt(7)
    s_cbranch_vccnz Lw_45
    s_waitcnt vmcnt(4)
Lw_45:
    buffer_load_dwordx4 v[252:255], v4, s[4:7], s20 offen offset:2176 nt
    s_add_u32 s20, s20, 16384
    s_waitcnt lgkmcnt(0)
    v_cmp_eq_u32 vcc, 1, v9
    v_mov_b32 v11, 143028
    s_mov_b32 s33, 2000000
Lsp_46:
    ds_read_b32 v10, v11
    s_waitcnt lgkmcnt(0)
    v_readfirstlane_b32 s32, v10
    s_nop 0
    s_cmp_ge_u32 s32, 4
    s_cbranch_scc1 Lsd_47
    s_sub_u32 s33, s33, 1
    s_cbranch_scc1 Lsd_47
    s_sleep 1
    s_branch Lsp_46
Lsd_47:
    s_lshl_b32 s34, s3, 13
    s_add_u32 m0, s34, 98304
    s_waitcnt vmcnt(7)
    s_cbranch_vccnz Lw_48
    s_waitcnt vmcnt(4)
Lw_48:
    buffer_load_dwordx4 v4, s[4:7], s20 offen offset:0 nt lds
    s_lshl_b32 s34, s3, 13
    s_add_u32 m0, s34, 99200
    s_waitcnt vmcnt(7)
    s_cbranch_vccnz Lw_49
    s_waitcnt vmcnt(4)
Lw_49:
    buffer_load_dwordx4 v4, s[4:7], s20 offen offset:128 nt lds
    v_mov_b32 v9, 143024
    ds_read_b32 v9, v9
    s_lshl_b32 s34, s3, 13
    s_add_u32 m0, s34, 98304
    s_waitcnt vmcnt(7)
    s_cbranch_vccnz Lw_50
    s_waitcnt vmcnt(4)
Lw_50:
    buffer_load_dwordx4 v4, s[4:7], s20 offen offset:2048 nt lds
    s_waitcnt lgkmcnt(0)
    v_cmp_eq_u32 vcc, 1, v9
    s_lshl_b32 s34, s3, 13
    s_add_u32 m0, s34, 99200
    s_waitcnt vmcnt(7)
    s_cbranch_vccnz Lw_51
    s_waitcnt vmcnt(4)
Lw_51:
    buffer_load_dwordx4 v4, s[4:7], s20 offen offset:2176 nt lds
    s_add_u32 s20, s20, 16384
    s_lshl_b32 s34, s3, 13
    s_add_u32 m0, s34, 102400
    s_waitcnt vmcnt(7)
    s_cbranch_vccnz Lw_52
    s_waitcnt vmcnt(4)
Lw_52:
    buffer_load_dwordx4 v4, s[4:7], s20 offen offset:0 nt lds
    v_mov_b32 v9, 143024
    ds_read_b32 v9, v9
    s_lshl_b32 s34, s3, 13
    s_add_u32 m0, s34, 103296
    s_waitcnt vmcnt(7)
    s_cbranch_vccnz Lw_53
    s_waitcnt vmcnt(4)
Lw_53:
    buffer_load_dwordx4 v4, s[4:7], s20 offen offset:128 nt lds
    s_waitcnt lgkmcnt(0)
    v_cmp_eq_u32 vcc, 1, v9
    s_lshl_b32 s34, s3, 13
    s_add_u32 m0, s34, 102400
    s_waitcnt vmcnt(7)
    s_cbranch_vccnz Lw_54
    s_waitcnt vmcnt(4)
Lw_54:
    buffer_load_dwordx4 v4, s[4:7], s20 offen offset:2048 nt lds
    s_lshl_b32 s34, s3, 13
    s_add_u32 m0, s34, 103296
    s_waitcnt vmcnt(7)
    s_cbranch_vccnz Lw_55
    s_waitcnt vmcnt(4)
Lw_55:
    buffer_load_dwordx4 v4, s[4:7], s20 offen offset:2176 nt lds
    s_add_u32 s20, s20, 16384
    v_mov_b32 v9, 143024
    ds_read_b32 v9, v9
    s_lshl_b32 s34, s3, 12
    s_add_u32 m0, s34, 143232
    s_waitcnt vmcnt(7)
    s_cbranch_vccnz Lw_56
    s_waitcnt vmcnt(4)
Lw_56:
    buffer_load_dwordx4 v3, s[8:11], s21 offen offset:0 nt lds
    s_waitcnt lgkmcnt(0)
    v_cmp_eq_u32 vcc, 1, v9
    s_lshl_b32 s34, s3, 12
    s_add_u32 m0, s34, 143232
    s_waitcnt vmcnt(7)
    s_cbranch_vccnz Lw_57
    s_waitcnt vmcnt(4)
Lw_57:
    buffer_load_dwordx4 v3, s[8:11], s21 offen offset:1024 nt lds
    s_lshl_b32 s34, s3, 12
    s_add_u32 m0, s34, 143232
    s_waitcnt vmcnt(7)
    s_cbranch_vccnz Lw_58
    s_waitcnt vmcnt(4)
Lw_58:
    buffer_load_dwordx4 v3, s[8:11], s21 offen offset:2048 nt lds
    v_mov_b32 v14, 10
    ds_write_b32 v15, v14
    v_mov_b32 v11, 142980
    s_mov_b32 s33, 2000000
Lsp_59:
    ds_read_b32 v10, v11
    s_waitcnt lgkmcnt(0)
    v_readfirstlane_b32 s32, v10
    s_nop 0
    s_cmp_ge_u32 s32, 4
    s_cbranch_scc1 Lsd_60
    s_sub_u32 s33, s33, 1
    s_cbranch_scc1 Lsd_60
    s_sleep 1
    s_branch Lsp_59
Lsd_60:
    v_and_b32 v10, 7, v1
    v_mul_u32_u24 v10, 272, v10
    v_lshl_add_u32 v10, v2, 5, v10
    v_lshrrev_b32 v11, 3, v1
    v_lshl_add_u32 v10, v11, 4, v10
    v_add_u32 v10, 139520, v10
    ds_read_b128 v[16:19], v10 offset:0
    ds_read_b128 v[20:23], v10 offset:128
    s_mov_b32 s22, 0x3db504f3
    s_mov_b32 s23, 0x3fb8aa3b
    s_mov_b32 s24, 0x05040100
    s_mov_b32 s25, 0x07060302
    v_mov_b32 v11, 142988
    ds_read_b32 v11, v11
    v_mov_b32 v6, 0xff800000
    s_waitcnt lgkmcnt(0)
    v_readfirstlane_b32 s31, v11
    v_mfma_f32_16x16x32_bf16 v[28:31], v[32:35], v[16:19], 0
    v_mfma_f32_16x16x32_bf16 v[24:27], v[40:43], v[16:19], 0
    v_mfma_f32_16x16x32_bf16 v[28:31], v[36:39], v[20:23], v[28:31]
    v_mfma_f32_16x16x32_bf16 v[24:27], v[44:47], v[20:23], v[24:27]
    s_nop 6
    v_add_f32_dpp v32, v29, v28 row_ror:8 row_mask:0xf bank_mask:0xf
    v_add_f32_dpp v33, v31, v30 row_ror:8 row_mask:0xf bank_mask:0xf
    v_add_f32_dpp v34, v25, v24 row_ror:8 row_mask:0xf bank_mask:0xf
    v_add_f32_dpp v35, v27, v26 row_ror:8 row_mask:0xf bank_mask:0xf
    v_cvt_pk_bf16_f32 v32, 0, v32
    v_cvt_pk_bf16_f32 v33, 0, v33
    v_cvt_pk_bf16_f32 v34, 0, v34
    v_cvt_pk_bf16_f32 v35, 0, v35
    v_mul_f32 v32, s22, v32
    v_mul_f32 v33, s22, v33
    v_mul_f32 v34, s22, v34
    v_mul_f32 v35, s22, v35
    v_cvt_pk_bf16_f32 v32, 0, v32
    v_cvt_pk_bf16_f32 v33, 0, v33
    v_cvt_pk_bf16_f32 v34, 0, v34
    v_cvt_pk_bf16_f32 v35, 0, v35
    v_max3_f32 v6, v6, v32, v33
    v_max3_f32 v6, v6, v34, v35
    v_mfma_f32_16x16x32_bf16 v[36:39], v[48:51], v[16:19], 0
    v_mfma_f32_16x16x32_bf16 v[28:31], v[56:59], v[16:19], 0
    v_mfma_f32_16x16x32_bf16 v[36:39], v[52:55], v[20:23], v[36:39]
    v_mfma_f32_16x16x32_bf16 v[28:31], v[60:63], v[20:23], v[28:31]
    v_mov_b32 v9, 143024
    ds_read_b32 v9, v9
    s_lshl_b32 s34, s3, 12
    s_add_u32 m0, s34, 143232
    s_waitcnt vmcnt(7)
    s_cbranch_vccnz Lw_61
    s_waitcnt vmcnt(4)
Lw_61:
    buffer_load_dwordx4 v3, s[8:11], s21 offen offset:3072 nt lds
    s_add_u32 s21, s21, 16384
    s_waitcnt lgkmcnt(0)
    v_cmp_eq_u32 vcc, 1, v9
    v_mfma_f32_16x16x32_bf16 v[40:43], v[64:67], v[16:19], 0
    v_mfma_f32_16x16x32_bf16 v[24:27], v[72:75], v[16:19], 0
    v_mfma_f32_16x16x32_bf16 v[40:43], v[68:71], v[20:23], v[40:43]
    v_mfma_f32_16x16x32_bf16 v[24:27], v[76:79], v[20:23], v[24:27]
    v_add_f32_dpp v36, v37, v36 row_ror:8 row_mask:0xf bank_mask:0xf
    v_add_f32_dpp v37, v39, v38 row_ror:8 row_mask:0xf bank_mask:0xf
    v_add_f32_dpp v38, v29, v28 row_ror:8 row_mask:0xf bank_mask:0xf
    v_add_f32_dpp v39, v31, v30 row_ror:8 row_mask:0xf bank_mask:0xf
    v_cvt_pk_bf16_f32 v36, 0, v36
    v_cvt_pk_bf16_f32 v37, 0, v37
    v_cvt_pk_bf16_f32 v38, 0, v38
    v_cvt_pk_bf16_f32 v39, 0, v39
    v_mul_f32 v36, s22, v36
    v_mul_f32 v37, s22, v37
    v_mul_f32 v38, s22, v38
    v_mul_f32 v39, s22, v39
    v_cvt_pk_bf16_f32 v36, 0, v36
    v_cvt_pk_bf16_f32 v37, 0, v37
    v_cvt_pk_bf16_f32 v38, 0, v38
    v_cvt_pk_bf16_f32 v39, 0, v39
    v_max3_f32 v6, v6, v36, v37
    v_max3_f32 v6, v6, v38, v39
    s_waitcnt vmcnt(7)
    s_cbranch_vccnz Lw_62
    s_waitcnt vmcnt(4)
Lw_62:
    buffer_load_dwordx4 v[48:51], v3, s[8:11], s21 offen offset:0 nt
    v_mfma_f32_16x16x32_bf16 v[44:47], v[80:83], v[16:19], 0
    v_mfma_f32_16x16x32_bf16 v[28:31], v[88:91], v[16:19], 0
    v_mfma_f32_16x16x32_bf16 v[44:47], v[84:87], v[20:23], v[44:47]
    v_mfma_f32_16x16x32_bf16 v[28:31], v[92:95], v[20:23], v[28:31]
    v_add_f32_dpp v40, v41, v40 row_ror:8 row_mask:0xf bank_mask:0xf
    v_add_f32_dpp v41, v43, v42 row_ror:8 row_mask:0xf bank_mask:0xf
    v_add_f32_dpp v42, v25, v24 row_ror:8 row_mask:0xf bank_mask:0xf
    v_add_f32_dpp v43, v27, v26 row_ror:8 row_mask:0xf bank_mask:0xf
    v_cvt_pk_bf16_f32 v40, 0, v40
    v_cvt_pk_bf16_f32 v41, 0, v41
    v_cvt_pk_bf16_f32 v42, 0, v42
    v_cvt_pk_bf16_f32 v43, 0, v43
    v_mul_f32 v40, s22, v40
    v_mul_f32 v41, s22, v41
    v_mul_f32 v42, s22, v42
    v_mul_f32 v43, s22, v43
    v_cvt_pk_bf16_f32 v40, 0, v40
    v_cvt_pk_bf16_f32 v41, 0, v41
    v_cvt_pk_bf16_f32 v42, 0, v42
    v_cvt_pk_bf16_f32 v43, 0, v43
    v_max3_f32 v6, v6, v40, v41
    v_max3_f32 v6, v6, v42, v43
    s_waitcnt vmcnt(7)
    s_cbranch_vccnz Lw_63
    s_waitcnt vmcnt(4)
Lw_63:
    buffer_load_dwordx4 v[52:55], v3, s[8:11], s21 offen offset:1024 nt
    v_mfma_f32_16x16x32_bf16 v[64:67], v[96:99], v[16:19], 0
    v_mfma_f32_16x16x32_bf16 v[24:27], v[104:107], v[16:19], 0
    v_mfma_f32_16x16x32_bf16 v[64:67], v[100:103], v[20:23], v[64:67]
    v_mfma_f32_16x16x32_bf16 v[24:27], v[108:111], v[20:23], v[24:27]
    v_add_f32_dpp v44, v45, v44 row_ror:8 row_mask:0xf bank_mask:0xf
    v_add_f32_dpp v45, v47, v46 row_ror:8 row_mask:0xf bank_mask:0xf
    v_add_f32_dpp v46, v29, v28 row_ror:8 row_mask:0xf bank_mask:0xf
    v_add_f32_dpp v47, v31, v30 row_ror:8 row_mask:0xf bank_mask:0xf
    v_cvt_pk_bf16_f32 v44, 0, v44
    v_cvt_pk_bf16_f32 v45, 0, v45
    v_cvt_pk_bf16_f32 v46, 0, v46
    v_cvt_pk_bf16_f32 v47, 0, v47
    v_mul_f32 v44, s22, v44
    v_mul_f32 v45, s22, v45
    v_mul_f32 v46, s22, v46
    v_mul_f32 v47, s22, v47
    v_cvt_pk_bf16_f32 v44, 0, v44
    v_cvt_pk_bf16_f32 v45, 0, v45
    v_cvt_pk_bf16_f32 v46, 0, v46
    v_cvt_pk_bf16_f32 v47, 0, v47
    v_max3_f32 v6, v6, v44, v45
    v_max3_f32 v6, v6, v46, v47
    v_mov_b32 v9, 143024
    ds_read_b32 v9, v9
    s_waitcnt vmcnt(7)
    s_cbranch_vccnz Lw_64
    s_waitcnt vmcnt(4)
Lw_64:
    buffer_load_dwordx4 v[56:59], v3, s[8:11], s21 offen offset:2048 nt
    s_waitcnt lgkmcnt(0)
    v_cmp_eq_u32 vcc, 1, v9
    v_mfma_f32_16x16x32_bf16 v[68:71], v[112:115], v[16:19], 0
    v_mfma_f32_16x16x32_bf16 v[28:31], v[120:123], v[16:19], 0
    v_mfma_f32_16x16x32_bf16 v[68:71], v[116:119], v[20:23], v[68:71]
    v_mfma_f32_16x16x32_bf16 v[28:31], v[124:127], v[20:23], v[28:31]
    v_add_f32_dpp v64, v65, v64 row_ror:8 row_mask:0xf bank_mask:0xf
    v_add_f32_dpp v65, v67, v66 row_ror:8 row_mask:0xf bank_mask:0xf
    v_add_f32_dpp v66, v25, v24 row_ror:8 row_mask:0xf bank_mask:0xf
    v_add_f32_dpp v67, v27, v26 row_ror:8 row_mask:0xf bank_mask:0xf
    v_cvt_pk_bf16_f32 v64, 0, v64
    v_cvt_pk_bf16_f32 v65, 0, v65
    v_cvt_pk_bf16_f32 v66, 0, v66
    v_cvt_pk_bf16_f32 v67, 0, v67
    v_mul_f32 v64, s22, v64
    v_mul_f32 v65, s22, v65
    v_mul_f32 v66, s22, v66
    v_mul_f32 v67, s22, v67
    v_cvt_pk_bf16_f32 v64, 0, v64
    v_cvt_pk_bf16_f32 v65, 0, v65
    v_cvt_pk_bf16_f32 v66, 0, v66
    v_cvt_pk_bf16_f32 v67, 0, v67
    v_max3_f32 v6, v6, v64, v65
    v_max3_f32 v6, v6, v66, v67
    s_waitcnt vmcnt(7)
    s_cbranch_vccnz Lw_65
    s_waitcnt vmcnt(4)
Lw_65:
    buffer_load_dwordx4 v[60:63], v3, s[8:11], s21 offen offset:3072 nt
    s_add_u32 s21, s21, 16384
    v_mfma_f32_16x16x32_bf16 v[72:75], v[128:131], v[16:19], 0
    v_mfma_f32_16x16x32_bf16 v[24:27], v[136:139], v[16:19], 0
    v_mfma_f32_16x16x32_bf16 v[72:75], v[132:135], v[20:23], v[72:75]
    v_mfma_f32_16x16x32_bf16 v[24:27], v[140:143], v[20:23], v[24:27]
    v_add_f32_dpp v68, v69, v68 row_ror:8 row_mask:0xf bank_mask:0xf
    v_add_f32_dpp v69, v71, v70 row_ror:8 row_mask:0xf bank_mask:0xf
    v_add_f32_dpp v70, v29, v28 row_ror:8 row_mask:0xf bank_mask:0xf
    v_add_f32_dpp v71, v31, v30 row_ror:8 row_mask:0xf bank_mask:0xf
    v_cvt_pk_bf16_f32 v68, 0, v68
    v_cvt_pk_bf16_f32 v69, 0, v69
    v_cvt_pk_bf16_f32 v70, 0, v70
    v_cvt_pk_bf16_f32 v71, 0, v71
    v_mul_f32 v68, s22, v68
    v_mul_f32 v69, s22, v69
    v_mul_f32 v70, s22, v70
    v_mul_f32 v71, s22, v71
    v_cvt_pk_bf16_f32 v68, 0, v68
    v_cvt_pk_bf16_f32 v69, 0, v69
    v_cvt_pk_bf16_f32 v70, 0, v70
    v_cvt_pk_bf16_f32 v71, 0, v71
    v_max3_f32 v6, v6, v68, v69
    v_max3_f32 v6, v6, v70, v71
    s_waitcnt vmcnt(7)
    s_cbranch_vccnz Lw_66
    s_waitcnt vmcnt(4)
Lw_66:
    buffer_load_dwordx4 v[112:115], v3, s[8:11], s21 offen offset:0 nt
    v_mfma_f32_16x16x32_bf16 v[76:79], v[144:147], v[16:19], 0
    v_mfma_f32_16x16x32_bf16 v[28:31], v[152:155], v[16:19], 0
    v_mfma_f32_16x16x32_bf16 v[76:79], v[148:151], v[20:23], v[76:79]
    v_mfma_f32_16x16x32_bf16 v[28:31], v[156:159], v[20:23], v[28:31]
    v_add_f32_dpp v72, v73, v72 row_ror:8 row_mask:0xf bank_mask:0xf
    v_add_f32_dpp v73, v75, v74 row_ror:8 row_mask:0xf bank_mask:0xf
    v_add_f32_dpp v74, v25, v24 row_ror:8 row_mask:0xf bank_mask:0xf
    v_add_f32_dpp v75, v27, v26 row_ror:8 row_mask:0xf bank_mask:0xf
    v_cvt_pk_bf16_f32 v72, 0, v72
    v_cvt_pk_bf16_f32 v73, 0, v73
    v_cvt_pk_bf16_f32 v74, 0, v74
    v_cvt_pk_bf16_f32 v75, 0, v75
    v_mul_f32 v72, s22, v72
    v_mul_f32 v73, s22, v73
    v_mul_f32 v74, s22, v74
    v_mul_f32 v75, s22, v75
    v_cvt_pk_bf16_f32 v72, 0, v72
    v_cvt_pk_bf16_f32 v73, 0, v73
    v_cvt_pk_bf16_f32 v74, 0, v74
    v_cvt_pk_bf16_f32 v75, 0, v75
    v_max3_f32 v6, v6, v72, v73
    v_max3_f32 v6, v6, v74, v75
    v_mov_b32 v9, 143024
    ds_read_b32 v9, v9
    s_waitcnt vmcnt(7)
    s_cbranch_vccnz Lw_67
    s_waitcnt vmcnt(4)
Lw_67:
    buffer_load_dwordx4 v[116:119], v3, s[8:11], s21 offen offset:1024 nt
    s_waitcnt lgkmcnt(0)
    v_cmp_eq_u32 vcc, 1, v9
    v_mfma_f32_16x16x32_bf16 v[80:83], v[160:163], v[16:19], 0
    v_mfma_f32_16x16x32_bf16 v[24:27], v[168:171], v[16:19], 0
    v_mfma_f32_16x16x32_bf16 v[80:83], v[164:167], v[20:23], v[80:83]
    v_mfma_f32_16x16x32_bf16 v[24:27], v[172:175], v[20:23], v[24:27]
    v_add_f32_dpp v76, v77, v76 row_ror:8 row_mask:0xf bank_mask:0xf
    v_add_f32_dpp v77, v79, v78 row_ror:8 row_mask:0xf bank_mask:0xf
    v_add_f32_dpp v78, v29, v28 row_ror:8 row_mask:0xf bank_mask:0xf
    v_add_f32_dpp v79, v31, v30 row_ror:8 row_mask:0xf bank_mask:0xf
    v_cvt_pk_bf16_f32 v76, 0, v76
    v_cvt_pk_bf16_f32 v77, 0, v77
    v_cvt_pk_bf16_f32 v78, 0, v78
    v_cvt_pk_bf16_f32 v79, 0, v79
    v_mul_f32 v76, s22, v76
    v_mul_f32 v77, s22, v77
    v_mul_f32 v78, s22, v78
    v_mul_f32 v79, s22, v79
    v_cvt_pk_bf16_f32 v76, 0, v76
    v_cvt_pk_bf16_f32 v77, 0, v77
    v_cvt_pk_bf16_f32 v78, 0, v78
    v_cvt_pk_bf16_f32 v79, 0, v79
    v_max3_f32 v6, v6, v76, v77
    v_max3_f32 v6, v6, v78, v79
    s_waitcnt vmcnt(7)
    s_cbranch_vccnz Lw_68
    s_waitcnt vmcnt(4)
Lw_68:
    buffer_load_dwordx4 v[120:123], v3, s[8:11], s21 offen offset:2048 nt
    v_mfma_f32_16x16x32_bf16 v[84:87], v[176:179], v[16:19], 0
    v_mfma_f32_16x16x32_bf16 v[28:31], v[184:187], v[16:19], 0
    v_mfma_f32_16x16x32_bf16 v[84:87], v[180:183], v[20:23], v[84:87]
    v_mfma_f32_16x16x32_bf16 v[28:31], v[188:191], v[20:23], v[28:31]
    v_add_f32_dpp v80, v81, v80 row_ror:8 row_mask:0xf bank_mask:0xf
    v_add_f32_dpp v81, v83, v82 row_ror:8 row_mask:0xf bank_mask:0xf
    v_add_f32_dpp v82, v25, v24 row_ror:8 row_mask:0xf bank_mask:0xf
    v_add_f32_dpp v83, v27, v26 row_ror:8 row_mask:0xf bank_mask:0xf
    v_cvt_pk_bf16_f32 v80, 0, v80
    v_cvt_pk_bf16_f32 v81, 0, v81
    v_cvt_pk_bf16_f32 v82, 0, v82
    v_cvt_pk_bf16_f32 v83, 0, v83
    v_mul_f32 v80, s22, v80
    v_mul_f32 v81, s22, v81
    v_mul_f32 v82, s22, v82
    v_mul_f32 v83, s22, v83
    v_cvt_pk_bf16_f32 v80, 0, v80
    v_cvt_pk_bf16_f32 v81, 0, v81
    v_cvt_pk_bf16_f32 v82, 0, v82
    v_cvt_pk_bf16_f32 v83, 0, v83
    v_max3_f32 v6, v6, v80, v81
    v_max3_f32 v6, v6, v82, v83
    s_waitcnt vmcnt(7)
    s_cbranch_vccnz Lw_69
    s_waitcnt vmcnt(4)
Lw_69:
    buffer_load_dwordx4 v[124:127], v3, s[8:11], s21 offen offset:3072 nt
    s_add_u32 s21, s21, 16384
    v_mfma_f32_16x16x32_bf16 v[88:91], v[192:195], v[16:19], 0
    v_mfma_f32_16x16x32_bf16 v[24:27], v[200:203], v[16:19], 0
    v_mfma_f32_16x16x32_bf16 v[88:91], v[196:199], v[20:23], v[88:91]
    v_mfma_f32_16x16x32_bf16 v[24:27], v[204:207], v[20:23], v[24:27]
    v_add_f32_dpp v84, v85, v84 row_ror:8 row_mask:0xf bank_mask:0xf
    v_add_f32_dpp v85, v87, v86 row_ror:8 row_mask:0xf bank_mask:0xf
    v_add_f32_dpp v86, v29, v28 row_ror:8 row_mask:0xf bank_mask:0xf
    v_add_f32_dpp v87, v31, v30 row_ror:8 row_mask:0xf bank_mask:0xf
    v_cvt_pk_bf16_f32 v84, 0, v84
    v_cvt_pk_bf16_f32 v85, 0, v85
    v_cvt_pk_bf16_f32 v86, 0, v86
    v_cvt_pk_bf16_f32 v87, 0, v87
    v_mul_f32 v84, s22, v84
    v_mul_f32 v85, s22, v85
    v_mul_f32 v86, s22, v86
    v_mul_f32 v87, s22, v87
    v_cvt_pk_bf16_f32 v84, 0, v84
    v_cvt_pk_bf16_f32 v85, 0, v85
    v_cvt_pk_bf16_f32 v86, 0, v86
    v_cvt_pk_bf16_f32 v87, 0, v87
    v_max3_f32 v6, v6, v84, v85
    v_max3_f32 v6, v6, v86, v87
    v_mov_b32 v9, 143024
    ds_read_b32 v9, v9
    s_waitcnt vmcnt(7)
    s_cbranch_vccnz Lw_70
    s_waitcnt vmcnt(4)
Lw_70:
    buffer_load_dwordx4 v[128:131], v3, s[8:11], s21 offen offset:0 nt
    s_waitcnt lgkmcnt(0)
    v_cmp_eq_u32 vcc, 1, v9
    v_mfma_f32_16x16x32_bf16 v[92:95], v[208:211], v[16:19], 0
    v_mfma_f32_16x16x32_bf16 v[28:31], v[216:219], v[16:19], 0
    v_mfma_f32_16x16x32_bf16 v[92:95], v[212:215], v[20:23], v[92:95]
    v_mfma_f32_16x16x32_bf16 v[28:31], v[220:223], v[20:23], v[28:31]
    v_add_f32_dpp v88, v89, v88 row_ror:8 row_mask:0xf bank_mask:0xf
    v_add_f32_dpp v89, v91, v90 row_ror:8 row_mask:0xf bank_mask:0xf
    v_add_f32_dpp v90, v25, v24 row_ror:8 row_mask:0xf bank_mask:0xf
    v_add_f32_dpp v91, v27, v26 row_ror:8 row_mask:0xf bank_mask:0xf
    v_cvt_pk_bf16_f32 v88, 0, v88
    v_cvt_pk_bf16_f32 v89, 0, v89
    v_cvt_pk_bf16_f32 v90, 0, v90
    v_cvt_pk_bf16_f32 v91, 0, v91
    v_mul_f32 v88, s22, v88
    v_mul_f32 v89, s22, v89
    v_mul_f32 v90, s22, v90
    v_mul_f32 v91, s22, v91
    v_cvt_pk_bf16_f32 v88, 0, v88
    v_cvt_pk_bf16_f32 v89, 0, v89
    v_cvt_pk_bf16_f32 v90, 0, v90
    v_cvt_pk_bf16_f32 v91, 0, v91
    v_max3_f32 v6, v6, v88, v89
    v_max3_f32 v6, v6, v90, v91
    s_waitcnt vmcnt(7)
    s_cbranch_vccnz Lw_71
    s_waitcnt vmcnt(4)
Lw_71:
    buffer_load_dwordx4 v[132:135], v3, s[8:11], s21 offen offset:1024 nt
    v_mfma_f32_16x16x32_bf16 v[96:99], v[224:227], v[16:19], 0
    v_mfma_f32_16x16x32_bf16 v[24:27], v[232:235], v[16:19], 0
    v_mfma_f32_16x16x32_bf16 v[96:99], v[228:231], v[20:23], v[96:99]
    v_mfma_f32_16x16x32_bf16 v[24:27], v[236:239], v[20:23], v[24:27]
    v_add_f32_dpp v92, v93, v92 row_ror:8 row_mask:0xf bank_mask:0xf
    v_add_f32_dpp v93, v95, v94 row_ror:8 row_mask:0xf bank_mask:0xf
    v_add_f32_dpp v94, v29, v28 row_ror:8 row_mask:0xf bank_mask:0xf
    v_add_f32_dpp v95, v31, v30 row_ror:8 row_mask:0xf bank_mask:0xf
    v_cvt_pk_bf16_f32 v92, 0, v92
    v_cvt_pk_bf16_f32 v93, 0, v93
    v_cvt_pk_bf16_f32 v94, 0, v94
    v_cvt_pk_bf16_f32 v95, 0, v95
    v_mul_f32 v92, s22, v92
    v_mul_f32 v93, s22, v93
    v_mul_f32 v94, s22, v94
    v_mul_f32 v95, s22, v95
    v_cvt_pk_bf16_f32 v92, 0, v92
    v_cvt_pk_bf16_f32 v93, 0, v93
    v_cvt_pk_bf16_f32 v94, 0, v94
    v_cvt_pk_bf16_f32 v95, 0, v95
    v_max3_f32 v6, v6, v92, v93
    v_max3_f32 v6, v6, v94, v95
    s_lshl_b32 s34, s3, 13
    s_add_u32 s34, s34, 98304
    v_add_u32 v14, s34, v3
    ds_read_b128 v[208:211], v14 offset:0
    ds_read_b128 v[212:215], v14 offset:1024
    ds_read_b128 v[216:219], v14 offset:2048
    ds_read_b128 v[220:223], v14 offset:3072
    s_waitcnt vmcnt(7)
    s_cbranch_vccnz Lw_72
    s_waitcnt vmcnt(4)
Lw_72:
    buffer_load_dwordx4 v[136:139], v3, s[8:11], s21 offen offset:2048 nt
    v_mfma_f32_16x16x32_bf16 v[100:103], v[240:243], v[16:19], 0
    v_mfma_f32_16x16x32_bf16 v[28:31], v[248:251], v[16:19], 0
    v_mfma_f32_16x16x32_bf16 v[100:103], v[244:247], v[20:23], v[100:103]
    v_mfma_f32_16x16x32_bf16 v[28:31], v[252:255], v[20:23], v[28:31]
    v_add_f32_dpp v96, v97, v96 row_ror:8 row_mask:0xf bank_mask:0xf
    v_add_f32_dpp v97, v99, v98 row_ror:8 row_mask:0xf bank_mask:0xf
    v_add_f32_dpp v98, v25, v24 row_ror:8 row_mask:0xf bank_mask:0xf
    v_add_f32_dpp v99, v27, v26 row_ror:8 row_mask:0xf bank_mask:0xf
    v_cvt_pk_bf16_f32 v96, 0, v96
    v_cvt_pk_bf16_f32 v97, 0, v97
    v_cvt_pk_bf16_f32 v98, 0, v98
    v_cvt_pk_bf16_f32 v99, 0, v99
    v_mul_f32 v96, s22, v96
    v_mul_f32 v97, s22, v97
    v_mul_f32 v98, s22, v98
    v_mul_f32 v99, s22, v99
    v_cvt_pk_bf16_f32 v96, 0, v96
    v_cvt_pk_bf16_f32 v97, 0, v97
    v_cvt_pk_bf16_f32 v98, 0, v98
    v_cvt_pk_bf16_f32 v99, 0, v99
    v_max3_f32 v6, v6, v96, v97
    v_max3_f32 v6, v6, v98, v99
    s_lshl_b32 s34, s3, 13
    s_add_u32 s34, s34, 102400
    v_add_u32 v14, s34, v3
    ds_read_b128 v[224:227], v14 offset:0
    ds_read_b128 v[228:231], v14 offset:1024
    ds_read_b128 v[232:235], v14 offset:2048
    ds_read_b128 v[236:239], v14 offset:3072
    v_mov_b32 v9, 143024
    ds_read_b32 v9, v9
    s_waitcnt vmcnt(7)
    s_cbranch_vccnz Lw_73
    s_waitcnt vmcnt(4)
Lw_73:
    buffer_load_dwordx4 v[140:143], v3, s[8:11], s21 offen offset:3072 nt
    s_add_u32 s21, s21, 16384
    s_waitcnt lgkmcnt(0)
    v_cmp_eq_u32 vcc, 1, v9
    s_waitcnt lgkmcnt(0)
    v_mfma_f32_16x16x32_bf16 v[104:107], v[208:211], v[16:19], 0
    v_mfma_f32_16x16x32_bf16 v[24:27], v[216:219], v[16:19], 0
    v_mfma_f32_16x16x32_bf16 v[104:107], v[212:215], v[20:23], v[104:107]
    v_mfma_f32_16x16x32_bf16 v[24:27], v[220:223], v[20:23], v[24:27]
    v_add_f32_dpp v100, v101, v100 row_ror:8 row_mask:0xf bank_mask:0xf
    v_add_f32_dpp v101, v103, v102 row_ror:8 row_mask:0xf bank_mask:0xf
    v_add_f32_dpp v102, v29, v28 row_ror:8 row_mask:0xf bank_mask:0xf
    v_add_f32_dpp v103, v31, v30 row_ror:8 row_mask:0xf bank_mask:0xf
    v_cvt_pk_bf16_f32 v100, 0, v100
    v_cvt_pk_bf16_f32 v101, 0, v101
    v_cvt_pk_bf16_f32 v102, 0, v102
    v_cvt_pk_bf16_f32 v103, 0, v103
    v_mul_f32 v100, s22, v100
    v_mul_f32 v101, s22, v101
    v_mul_f32 v102, s22, v102
    v_mul_f32 v103, s22, v103
    v_cvt_pk_bf16_f32 v100, 0, v100
    v_cvt_pk_bf16_f32 v101, 0, v101
    v_cvt_pk_bf16_f32 v102, 0, v102
    v_cvt_pk_bf16_f32 v103, 0, v103
    v_max3_f32 v6, v6, v100, v101
    v_max3_f32 v6, v6, v102, v103
    s_waitcnt vmcnt(7)
    s_cbranch_vccnz Lw_74
    s_waitcnt vmcnt(4)
Lw_74:
    buffer_load_dwordx4 v[144:147], v3, s[8:11], s21 offen offset:0 nt
    s_waitcnt lgkmcnt(0)
    v_mfma_f32_16x16x32_bf16 v[108:111], v[224:227], v[16:19], 0
    v_mfma_f32_16x16x32_bf16 v[28:31], v[232:235], v[16:19], 0
    v_mfma_f32_16x16x32_bf16 v[108:111], v[228:231], v[20:23], v[108:111]
    v_mfma_f32_16x16x32_bf16 v[28:31], v[236:239], v[20:23], v[28:31]
    v_add_f32_dpp v104, v105, v104 row_ror:8 row_mask:0xf bank_mask:0xf
    v_add_f32_dpp v105, v107, v106 row_ror:8 row_mask:0xf bank_mask:0xf
    v_add_f32_dpp v106, v25, v24 row_ror:8 row_mask:0xf bank_mask:0xf
    v_add_f32_dpp v107, v27, v26 row_ror:8 row_mask:0xf bank_mask:0xf
    v_cvt_pk_bf16_f32 v104, 0, v104
    v_cvt_pk_bf16_f32 v105, 0, v105
    v_cvt_pk_bf16_f32 v106, 0, v106
    v_cvt_pk_bf16_f32 v107, 0, v107
    v_mul_f32 v104, s22, v104
    v_mul_f32 v105, s22, v105
    v_mul_f32 v106, s22, v106
    v_mul_f32 v107, s22, v107
    v_cvt_pk_bf16_f32 v104, 0, v104
    v_cvt_pk_bf16_f32 v105, 0, v105
    v_cvt_pk_bf16_f32 v106, 0, v106
    v_cvt_pk_bf16_f32 v107, 0, v107
    v_max3_f32 v6, v6, v104, v105
    v_max3_f32 v6, v6, v106, v107
    s_waitcnt vmcnt(7)
    s_cbranch_vccnz Lw_75
    s_waitcnt vmcnt(4)
Lw_75:
    buffer_load_dwordx4 v[148:151], v3, s[8:11], s21 offen offset:1024 nt
    s_lshl_b32 s34, s3, 12
    s_add_u32 s34, s34, 143232
    v_add_u32 v14, s34, v3
    ds_read_b128 v[240:243], v14 offset:0
    ds_read_b128 v[244:247], v14 offset:1024
    ds_read_b128 v[248:251], v14 offset:2048
    ds_read_b128 v[252:255], v14 offset:3072
    v_add_f32_dpp v108, v109, v108 row_ror:8 row_mask:0xf bank_mask:0xf
    v_add_f32_dpp v109, v111, v110 row_ror:8 row_mask:0xf bank_mask:0xf
    v_add_f32_dpp v110, v29, v28 row_ror:8 row_mask:0xf bank_mask:0xf
    v_add_f32_dpp v111, v31, v30 row_ror:8 row_mask:0xf bank_mask:0xf
    v_cvt_pk_bf16_f32 v108, 0, v108
    v_cvt_pk_bf16_f32 v109, 0, v109
    v_cvt_pk_bf16_f32 v110, 0, v110
    v_cvt_pk_bf16_f32 v111, 0, v111
    v_mul_f32 v108, s22, v108
    v_mul_f32 v109, s22, v109
    v_mul_f32 v110, s22, v110
    v_mul_f32 v111, s22, v111
    v_cvt_pk_bf16_f32 v108, 0, v108
    v_cvt_pk_bf16_f32 v109, 0, v109
    v_cvt_pk_bf16_f32 v110, 0, v110
    v_cvt_pk_bf16_f32 v111, 0, v111
    v_max3_f32 v6, v6, v108, v109
    v_max3_f32 v6, v6, v110, v111
    v_mov_b32 v10, v6
    s_nop 1
    v_permlane32_swap_b32 v6, v10
    v_max_f32 v6, v6, v10
    v_mov_b32 v10, v6
    s_nop 1
    v_permlane16_swap_b32 v6, v10
    v_max_f32 v6, v6, v10
    v_mul_f32 v8, s23, v6
    v_mov_b32 v7, 0
    v_mov_b32 v11, 0
    v_mov_b32 v9, 143024
    ds_read_b32 v9, v9
    s_waitcnt vmcnt(7)
    s_cbranch_vccnz Lw_76
    s_waitcnt vmcnt(4)
Lw_76:
    buffer_load_dwordx4 v[152:155], v3, s[8:11], s21 offen offset:2048 nt
    v_mov_b32 v14, 11
    ds_write_b32 v15, v14
    s_waitcnt lgkmcnt(0)
    v_cmp_eq_u32 vcc, 1, v9
    v_fma_f32 v32, v32, s23, -v8
    v_fma_f32 v33, v33, s23, -v8
    v_fma_f32 v34, v34, s23, -v8
    v_fma_f32 v35, v35, s23, -v8
    v_exp_f32 v32, v32
    v_exp_f32 v33, v33
    v_exp_f32 v34, v34
    v_exp_f32 v35, v35
    v_add_f32 v7, v7, v32
    v_add_f32 v11, v11, v33
    v_add_f32 v7, v7, v34
    v_add_f32 v11, v11, v35
    v_cvt_pk_bf16_f32 v32, v32, v33
    v_cvt_pk_bf16_f32 v33, v34, v35
    v_fma_f32 v36, v36, s23, -v8
    v_fma_f32 v37, v37, s23, -v8
    v_fma_f32 v38, v38, s23, -v8
    v_fma_f32 v39, v39, s23, -v8
    v_exp_f32 v36, v36
    v_exp_f32 v37, v37
    v_exp_f32 v38, v38
    v_exp_f32 v39, v39
    v_add_f32 v7, v7, v36
    v_add_f32 v11, v11, v37
    v_add_f32 v7, v7, v38
    v_add_f32 v11, v11, v39
    v_cvt_pk_bf16_f32 v34, v36, v37
    v_cvt_pk_bf16_f32 v35, v38, v39
    s_waitcnt vmcnt(7)
    s_cbranch_vccnz Lw_77
    s_waitcnt vmcnt(4)
Lw_77:
    buffer_load_dwordx4 v[156:159], v3, s[8:11], s21 offen offset:3072 nt
    s_add_u32 s21, s21, 16384
    v_fma_f32 v40, v40, s23, -v8
    v_fma_f32 v41, v41, s23, -v8
    v_fma_f32 v42, v42, s23, -v8
    v_fma_f32 v43, v43, s23, -v8
    v_exp_f32 v40, v40
    v_exp_f32 v41, v41
    v_exp_f32 v42, v42
    v_exp_f32 v43, v43
    v_add_f32 v7, v7, v40
    v_add_f32 v11, v11, v41
    v_add_f32 v7, v7, v42
    v_add_f32 v11, v11, v43
    v_cvt_pk_bf16_f32 v36, v40, v41
    v_cvt_pk_bf16_f32 v37, v42, v43
    v_fma_f32 v44, v44, s23, -v8
    v_fma_f32 v45, v45, s23, -v8
    v_fma_f32 v46, v46, s23, -v8
    v_fma_f32 v47, v47, s23, -v8
    v_exp_f32 v44, v44
    v_exp_f32 v45, v45
    v_exp_f32 v46, v46
    v_exp_f32 v47, v47
    v_add_f32 v7, v7, v44
    v_add_f32 v11, v11, v45
    v_add_f32 v7, v7, v46
    v_add_f32 v11, v11, v47
    v_cvt_pk_bf16_f32 v38, v44, v45
    v_cvt_pk_bf16_f32 v39, v46, v47
    s_waitcnt vmcnt(7)
    s_cbranch_vccnz Lw_78
    s_waitcnt vmcnt(4)
Lw_78:
    buffer_load_dwordx4 v[160:163], v3, s[8:11], s21 offen offset:0 nt
    v_fma_f32 v64, v64, s23, -v8
    v_fma_f32 v65, v65, s23, -v8
    v_fma_f32 v66, v66, s23, -v8
    v_fma_f32 v67, v67, s23, -v8
    v_exp_f32 v64, v64
    v_exp_f32 v65, v65
    v_exp_f32 v66, v66
    v_exp_f32 v67, v67
    v_add_f32 v7, v7, v64
    v_add_f32 v11, v11, v65
    v_add_f32 v7, v7, v66
    v_add_f32 v11, v11, v67
    v_cvt_pk_bf16_f32 v40, v64, v65
    v_cvt_pk_bf16_f32 v41, v66, v67
    v_fma_f32 v68, v68, s23, -v8
    v_fma_f32 v69, v69, s23, -v8
    v_fma_f32 v70, v70, s23, -v8
    v_fma_f32 v71, v71, s23, -v8
    v_exp_f32 v68, v68
    v_exp_f32 v69, v69
    v_exp_f32 v70, v70
    v_exp_f32 v71, v71
    v_add_f32 v7, v7, v68
    v_add_f32 v11, v11, v69
    v_add_f32 v7, v7, v70
    v_add_f32 v11, v11, v71
    v_cvt_pk_bf16_f32 v42, v68, v69
    v_cvt_pk_bf16_f32 v43, v70, v71
    v_mov_b32 v9, 143024
    ds_read_b32 v9, v9
    s_waitcnt vmcnt(7)
    s_cbranch_vccnz Lw_79
    s_waitcnt vmcnt(4)
Lw_79:
    buffer_load_dwordx4 v[164:167], v3, s[8:11], s21 offen offset:1024 nt
    s_waitcnt lgkmcnt(0)
    v_cmp_eq_u32 vcc, 1, v9
    v_fma_f32 v72, v72, s23, -v8
    v_fma_f32 v73, v73, s23, -v8
    v_fma_f32 v74, v74, s23, -v8
    v_fma_f32 v75, v75, s23, -v8
    v_exp_f32 v72, v72
    v_exp_f32 v73, v73
    v_exp_f32 v74, v74
    v_exp_f32 v75, v75
    v_add_f32 v7, v7, v72
    v_add_f32 v11, v11, v73
    v_add_f32 v7, v7, v74
    v_add_f32 v11, v11, v75
    v_cvt_pk_bf16_f32 v44, v72, v73
    v_cvt_pk_bf16_f32 v45, v74, v75
    v_fma_f32 v76, v76, s23, -v8
    v_fma_f32 v77, v77, s23, -v8
    v_fma_f32 v78, v78, s23, -v8
    v_fma_f32 v79, v79, s23, -v8
    v_exp_f32 v76, v76
    v_exp_f32 v77, v77
    v_exp_f32 v78, v78
    v_exp_f32 v79, v79
    v_add_f32 v7, v7, v76
    v_add_f32 v11, v11, v77
    v_add_f32 v7, v7, v78
    v_add_f32 v11, v11, v79
    v_cvt_pk_bf16_f32 v46, v76, v77
    v_cvt_pk_bf16_f32 v47, v78, v79
    s_waitcnt vmcnt(7)
    s_cbranch_vccnz Lw_80
    s_waitcnt vmcnt(4)
Lw_80:
    buffer_load_dwordx4 v[168:171], v3, s[8:11], s21 offen offset:2048 nt
    v_fma_f32 v80, v80, s23, -v8
    v_fma_f32 v81, v81, s23, -v8
    v_fma_f32 v82, v82, s23, -v8
    v_fma_f32 v83, v83, s23, -v8
    v_exp_f32 v80, v80
    v_exp_f32 v81, v81
    v_exp_f32 v82, v82
    v_exp_f32 v83, v83
    v_add_f32 v7, v7, v80
    v_add_f32 v11, v11, v81
    v_add_f32 v7, v7, v82
    v_add_f32 v11, v11, v83
    v_cvt_pk_bf16_f32 v64, v80, v81
    v_cvt_pk_bf16_f32 v65, v82, v83
    v_fma_f32 v84, v84, s23, -v8
    v_fma_f32 v85, v85, s23, -v8
    v_fma_f32 v86, v86, s23, -v8
    v_fma_f32 v87, v87, s23, -v8
    v_exp_f32 v84, v84
    v_exp_f32 v85, v85
    v_exp_f32 v86, v86
    v_exp_f32 v87, v87
    v_add_f32 v7, v7, v84
    v_add_f32 v11, v11, v85
    v_add_f32 v7, v7, v86
    v_add_f32 v11, v11, v87
    v_cvt_pk_bf16_f32 v66, v84, v85
    v_cvt_pk_bf16_f32 v67, v86, v87
    s_waitcnt vmcnt(7)
    s_cbranch_vccnz Lw_81
    s_waitcnt vmcnt(4)
Lw_81:
    buffer_load_dwordx4 v[172:175], v3, s[8:11], s21 offen offset:3072 nt
    s_add_u32 s21, s21, 16384
    v_fma_f32 v88, v88, s23, -v8
    v_fma_f32 v89, v89, s23, -v8
    v_fma_f32 v90, v90, s23, -v8
    v_fma_f32 v91, v91, s23, -v8
    v_exp_f32 v88, v88
    v_exp_f32 v89, v89
    v_exp_f32 v90, v90
    v_exp_f32 v91, v91
    v_add_f32 v7, v7, v88
    v_add_f32 v11, v11, v89
    v_add_f32 v7, v7, v90
    v_add_f32 v11, v11, v91
    v_cvt_pk_bf16_f32 v68, v88, v89
    v_cvt_pk_bf16_f32 v69, v90, v91
    v_fma_f32 v92, v92, s23, -v8
    v_fma_f32 v93, v93, s23, -v8
    v_fma_f32 v94, v94, s23, -v8
    v_fma_f32 v95, v95, s23, -v8
    v_exp_f32 v92, v92
    v_exp_f32 v93, v93
    v_exp_f32 v94, v94
    v_exp_f32 v95, v95
    v_add_f32 v7, v7, v92
    v_add_f32 v11, v11, v93
    v_add_f32 v7, v7, v94
    v_add_f32 v11, v11, v95
    v_cvt_pk_bf16_f32 v70, v92, v93
    v_cvt_pk_bf16_f32 v71, v94, v95
    v_mov_b32 v9, 143024
    ds_read_b32 v9, v9
    s_waitcnt vmcnt(7)
    s_cbranch_vccnz Lw_82
    s_waitcnt vmcnt(4)
Lw_82:
    buffer_load_dwordx4 v[176:179], v3, s[8:11], s21 offen offset:0 nt
    s_waitcnt lgkmcnt(0)
    v_cmp_eq_u32 vcc, 1, v9
    v_fma_f32 v96, v96, s23, -v8
    v_fma_f32 v97, v97, s23, -v8
    v_fma_f32 v98, v98, s23, -v8
    v_fma_f32 v99, v99, s23, -v8
    v_exp_f32 v96, v96
    v_exp_f32 v97, v97
    v_exp_f32 v98, v98
    v_exp_f32 v99, v99
    v_add_f32 v7, v7, v96
    v_add_f32 v11, v11, v97
    v_add_f32 v7, v7, v98
    v_add_f32 v11, v11, v99
    v_cvt_pk_bf16_f32 v72, v96, v97
    v_cvt_pk_bf16_f32 v73, v98, v99
    v_fma_f32 v100, v100, s23, -v8
    v_fma_f32 v101, v101, s23, -v8
    v_fma_f32 v102, v102, s23, -v8
    v_fma_f32 v103, v103, s23, -v8
    v_exp_f32 v100, v100
    v_exp_f32 v101, v101
    v_exp_f32 v102, v102
    v_exp_f32 v103, v103
    v_add_f32 v7, v7, v100
    v_add_f32 v11, v11, v101
    v_add_f32 v7, v7, v102
    v_add_f32 v11, v11, v103
    v_cvt_pk_bf16_f32 v74, v100, v101
    v_cvt_pk_bf16_f32 v75, v102, v103
    s_waitcnt vmcnt(7)
    s_cbranch_vccnz Lw_83
    s_waitcnt vmcnt(4)
Lw_83:
    buffer_load_dwordx4 v[180:183], v3, s[8:11], s21 offen offset:1024 nt
    v_fma_f32 v104, v104, s23, -v8
    v_fma_f32 v105, v105, s23, -v8
    v_fma_f32 v106, v106, s23, -v8
    v_fma_f32 v107, v107, s23, -v8
    v_exp_f32 v104, v104
    v_exp_f32 v105, v105
    v_exp_f32 v106, v106
    v_exp_f32 v107, v107
    v_add_f32 v7, v7, v104
    v_add_f32 v11, v11, v105
    v_add_f32 v7, v7, v106
    v_add_f32 v11, v11, v107
    v_cvt_pk_bf16_f32 v76, v104, v105
    v_cvt_pk_bf16_f32 v77, v106, v107
    v_fma_f32 v108, v108, s23, -v8
    v_fma_f32 v109, v109, s23, -v8
    v_fma_f32 v110, v110, s23, -v8
    v_fma_f32 v111, v111, s23, -v8
    v_exp_f32 v108, v108
    v_exp_f32 v109, v109
    v_exp_f32 v110, v110
    v_exp_f32 v111, v111
    v_add_f32 v7, v7, v108
    v_add_f32 v11, v11, v109
    v_add_f32 v7, v7, v110
    v_add_f32 v11, v11, v111
    v_cvt_pk_bf16_f32 v78, v108, v109
    v_cvt_pk_bf16_f32 v79, v110, v111
    v_add_f32 v7, v7, v11
    v_mov_b32 v10, v7
    s_nop 1
    v_permlane32_swap_b32 v7, v10
    v_add_f32 v7, v7, v10
    v_mov_b32 v10, v7
    s_nop 1
    v_permlane16_swap_b32 v7, v10
    v_add_f32 v7, v7, v10
    v_lshrrev_b32 v14, 1, v3
    s_lshl_b32 s26, s69, 8
    s_lshl_b32 s27, s3, 6
    s_add_u32 s26, s26, s27
    s_add_u32 s26, s26, 1310720
    s_mov_b64 exec, 0xff
    s_cmp_eq_u32 s31, 0
    s_cbranch_scc1 L_mlx
    buffer_store_dwordx2 v[6:7], v14, s[12:15], s26 offen
    s_branch L_mly
L_mlx:
    buffer_store_dwordx2 v[6:7], v14, s[12:15], s26 offen sc1
L_mly:
    s_lshl_b32 s27, s3, 2
    s_add_u32 s27, s27, 143104
    v_add_u32 v14, s27, v3
    ds_write_b32 v14, v6
    s_mov_b64 exec, -1
    s_waitcnt vmcnt(7)
    s_cbranch_vccnz Lw_84
    s_waitcnt vmcnt(4)
Lw_84:
    buffer_load_dwordx4 v[184:187], v3, s[8:11], s21 offen offset:2048 nt
    s_waitcnt lgkmcnt(0)
    v_perm_b32 v16, v244, v240, s24
    v_perm_b32 v18, v244, v240, s25
    v_perm_b32 v20, v245, v241, s24
    v_perm_b32 v22, v245, v241, s25
    v_perm_b32 v24, v246, v242, s24
    v_perm_b32 v26, v246, v242, s25
    v_perm_b32 v28, v247, v243, s24
    v_perm_b32 v30, v247, v243, s25
    v_perm_b32 v17, v252, v248, s24
    v_perm_b32 v19, v252, v248, s25
    v_perm_b32 v21, v253, v249, s24
    v_perm_b32 v23, v253, v249, s25
    v_perm_b32 v25, v254, v250, s24
    v_perm_b32 v27, v254, v250, s25
    v_perm_b32 v29, v255, v251, s24
    v_perm_b32 v31, v255, v251, s25
    v_mov_b32 v9, 143024
    ds_read_b32 v9, v9
    s_waitcnt vmcnt(7)
    s_cbranch_vccnz Lw_85
    s_waitcnt vmcnt(4)
Lw_85:
    buffer_load_dwordx4 v[188:191], v3, s[8:11], s21 offen offset:3072 nt
    s_add_u32 s21, s21, 16384
    s_waitcnt lgkmcnt(0)
    v_cmp_eq_u32 vcc, 1, v9
    v_mfma_f32_16x16x16_bf16 v[80:83], v[16:17], v[32:33], 0
    v_mfma_f32_16x16x16_bf16 v[84:87], v[18:19], v[32:33], 0
    v_mfma_f32_16x16x16_bf16 v[88:91], v[20:21], v[32:33], 0
    v_mfma_f32_16x16x16_bf16 v[92:95], v[22:23], v[32:33], 0
    v_mfma_f32_16x16x16_bf16 v[96:99], v[24:25], v[32:33], 0
    v_mfma_f32_16x16x16_bf16 v[100:103], v[26:27], v[32:33], 0
    v_mfma_f32_16x16x16_bf16 v[104:107], v[28:29], v[32:33], 0
    v_mfma_f32_16x16x16_bf16 v[108:111], v[30:31], v[32:33], 0
    s_waitcnt vmcnt(7)
    s_cbranch_vccnz Lw_86
    s_waitcnt vmcnt(4)
Lw_86:
    buffer_load_dwordx4 v[192:195], v3, s[8:11], s21 offen offset:0 nt
    v_perm_b32 v16, v52, v48, s24
    v_perm_b32 v18, v52, v48, s25
    v_perm_b32 v20, v53, v49, s24
    v_perm_b32 v22, v53, v49, s25
    v_perm_b32 v24, v54, v50, s24
    v_perm_b32 v26, v54, v50, s25
    v_perm_b32 v28, v55, v51, s24
    v_perm_b32 v30, v55, v51, s25
    v_perm_b32 v17, v60, v56, s24
    v_perm_b32 v19, v60, v56, s25
    v_perm_b32 v21, v61, v57, s24
    v_perm_b32 v23, v61, v57, s25
    v_perm_b32 v25, v62, v58, s24
    v_perm_b32 v27, v62, v58, s25
    v_perm_b32 v29, v63, v59, s24
    v_perm_b32 v31, v63, v59, s25
    s_waitcnt vmcnt(7)
    s_cbranch_vccnz Lw_87
    s_waitcnt vmcnt(4)
Lw_87:
    buffer_load_dwordx4 v[196:199], v3, s[8:11], s21 offen offset:1024 nt
    v_mfma_f32_16x16x16_bf16 v[80:83], v[16:17], v[34:35], v[80:83]
    v_mfma_f32_16x16x16_bf16 v[84:87], v[18:19], v[34:35], v[84:87]
    v_mfma_f32_16x16x16_bf16 v[88:91], v[20:21], v[34:35], v[88:91]
    v_mfma_f32_16x16x16_bf16 v[92:95], v[22:23], v[34:35], v[92:95]
    v_mfma_f32_16x16x16_bf16 v[96:99], v[24:25], v[34:35], v[96:99]
    v_mfma_f32_16x16x16_bf16 v[100:103], v[26:27], v[34:35], v[100:103]
    v_mfma_f32_16x16x16_bf16 v[104:107], v[28:29], v[34:35], v[104:107]
    v_mfma_f32_16x16x16_bf16 v[108:111], v[30:31], v[34:35], v[108:111]
    v_mov_b32 v9, 143024
    ds_read_b32 v9, v9
    s_waitcnt vmcnt(7)
    s_cbranch_vccnz Lw_88
    s_waitcnt vmcnt(4)
Lw_88:
    buffer_load_dwordx4 v[200:203], v3, s[8:11], s21 offen offset:2048 nt
    s_waitcnt lgkmcnt(0)
    v_cmp_eq_u32 vcc, 1, v9
    v_perm_b32 v16, v116, v112, s24
    v_perm_b32 v18, v116, v112, s25
    v_perm_b32 v20, v117, v113, s24
    v_perm_b32 v22, v117, v113, s25
    v_perm_b32 v24, v118, v114, s24
    v_perm_b32 v26, v118, v114, s25
    v_perm_b32 v28, v119, v115, s24
    v_perm_b32 v30, v119, v115, s25
    v_perm_b32 v17, v124, v120, s24
    v_perm_b32 v19, v124, v120, s25
    v_perm_b32 v21, v125, v121, s24
    v_perm_b32 v23, v125, v121, s25
    v_perm_b32 v25, v126, v122, s24
    v_perm_b32 v27, v126, v122, s25
    v_perm_b32 v29, v127, v123, s24
    v_perm_b32 v31, v127, v123, s25
    s_waitcnt vmcnt(7)
    s_cbranch_vccnz Lw_89
    s_waitcnt vmcnt(4)
Lw_89:
    buffer_load_dwordx4 v[204:207], v3, s[8:11], s21 offen offset:3072 nt
    s_add_u32 s21, s21, 16384
    v_mfma_f32_16x16x16_bf16 v[80:83], v[16:17], v[36:37], v[80:83]
    v_mfma_f32_16x16x16_bf16 v[84:87], v[18:19], v[36:37], v[84:87]
    v_mfma_f32_16x16x16_bf16 v[88:91], v[20:21], v[36:37], v[88:91]
    v_mfma_f32_16x16x16_bf16 v[92:95], v[22:23], v[36:37], v[92:95]
    v_mfma_f32_16x16x16_bf16 v[96:99], v[24:25], v[36:37], v[96:99]
    v_mfma_f32_16x16x16_bf16 v[100:103], v[26:27], v[36:37], v[100:103]
    v_mfma_f32_16x16x16_bf16 v[104:107], v[28:29], v[36:37], v[104:107]
    v_mfma_f32_16x16x16_bf16 v[108:111], v[30:31], v[36:37], v[108:111]
    s_waitcnt vmcnt(7)
    s_cbranch_vccnz Lw_90
    s_waitcnt vmcnt(4)
Lw_90:
    buffer_load_dwordx4 v[208:211], v3, s[8:11], s21 offen offset:0 nt
    v_mov_b32 v14, 12
    ds_write_b32 v15, v14
    v_perm_b32 v16, v132, v128, s24
    v_perm_b32 v18, v132, v128, s25
    v_perm_b32 v20, v133, v129, s24
    v_perm_b32 v22, v133, v129, s25
    v_perm_b32 v24, v134, v130, s24
    v_perm_b32 v26, v134, v130, s25
    v_perm_b32 v28, v135, v131, s24
    v_perm_b32 v30, v135, v131, s25
    v_perm_b32 v17, v140, v136, s24
    v_perm_b32 v19, v140, v136, s25
    v_perm_b32 v21, v141, v137, s24
    v_perm_b32 v23, v141, v137, s25
    v_perm_b32 v25, v142, v138, s24
    v_perm_b32 v27, v142, v138, s25
    v_perm_b32 v29, v143, v139, s24
    v_perm_b32 v31, v143, v139, s25
    v_lshlrev_b32 v10, 2, v2
    v_and_b32 v10, 4, v10
    v_and_b32 v11, 7, v1
    v_xor_b32 v10, v10, v11
    s_lshl_b32 s26, s3, 13
    s_add_u32 s26, s26, 98304
    v_lshl_add_u32 v11, v2, 10, s26
    v_xor_b32 v240, 0, v10
    v_lshl_add_u32 v240, v240, 4, v11
    v_xor_b32 v241, 1, v10
    v_lshl_add_u32 v241, v241, 4, v11
    v_xor_b32 v242, 2, v10
    v_lshl_add_u32 v242, v242, 4, v11
    v_xor_b32 v243, 3, v10
    v_lshl_add_u32 v243, v243, 4, v11
    v_mov_b32 v9, 143024
    ds_read_b32 v9, v9
    s_waitcnt vmcnt(7)
    s_cbranch_vccnz Lw_91
    s_waitcnt vmcnt(4)
Lw_91:
    buffer_load_dwordx4 v[212:215], v3, s[8:11], s21 offen offset:1024 nt
    s_waitcnt lgkmcnt(0)
    v_cmp_eq_u32 vcc, 1, v9
    v_mfma_f32_16x16x16_bf16 v[80:83], v[16:17], v[38:39], v[80:83]
    v_mfma_f32_16x16x16_bf16 v[84:87], v[18:19], v[38:39], v[84:87]
    v_mfma_f32_16x16x16_bf16 v[88:91], v[20:21], v[38:39], v[88:91]
    v_mfma_f32_16x16x16_bf16 v[92:95], v[22:23], v[38:39], v[92:95]
    v_mfma_f32_16x16x16_bf16 v[96:99], v[24:25], v[38:39], v[96:99]
    v_mfma_f32_16x16x16_bf16 v[100:103], v[26:27], v[38:39], v[100:103]
    v_mfma_f32_16x16x16_bf16 v[104:107], v[28:29], v[38:39], v[104:107]
    v_mfma_f32_16x16x16_bf16 v[108:111], v[30:31], v[38:39], v[108:111]
    s_waitcnt vmcnt(7)
    s_cbranch_vccnz Lw_92
    s_waitcnt vmcnt(4)
Lw_92:
    buffer_load_dwordx4 v[216:219], v3, s[8:11], s21 offen offset:2048 nt
    v_perm_b32 v16, v148, v144, s24
    v_perm_b32 v18, v148, v144, s25
    v_perm_b32 v20, v149, v145, s24
    v_perm_b32 v22, v149, v145, s25
    v_perm_b32 v24, v150, v146, s24
    v_perm_b32 v26, v150, v146, s25
    v_perm_b32 v28, v151, v147, s24
    v_perm_b32 v30, v151, v147, s25
    v_perm_b32 v17, v156, v152, s24
    v_perm_b32 v19, v156, v152, s25
    v_perm_b32 v21, v157, v153, s24
    v_perm_b32 v23, v157, v153, s25
    v_perm_b32 v25, v158, v154, s24
    v_perm_b32 v27, v158, v154, s25
    v_perm_b32 v29, v159, v155, s24
    v_perm_b32 v31, v159, v155, s25
    s_waitcnt vmcnt(7)
    s_cbranch_vccnz Lw_93
    s_waitcnt vmcnt(4)
Lw_93:
    buffer_load_dwordx4 v[220:223], v3, s[8:11], s21 offen offset:3072 nt
    s_add_u32 s21, s21, 16384
    v_mfma_f32_16x16x16_bf16 v[80:83], v[16:17], v[40:41], v[80:83]
    v_mfma_f32_16x16x16_bf16 v[84:87], v[18:19], v[40:41], v[84:87]
    v_mfma_f32_16x16x16_bf16 v[88:91], v[20:21], v[40:41], v[88:91]
    v_mfma_f32_16x16x16_bf16 v[92:95], v[22:23], v[40:41], v[92:95]
    v_mfma_f32_16x16x16_bf16 v[96:99], v[24:25], v[40:41], v[96:99]
    v_mfma_f32_16x16x16_bf16 v[100:103], v[26:27], v[40:41], v[100:103]
    v_mfma_f32_16x16x16_bf16 v[104:107], v[28:29], v[40:41], v[104:107]
    v_mfma_f32_16x16x16_bf16 v[108:111], v[30:31], v[40:41], v[108:111]
    v_mov_b32 v9, 143024
    ds_read_b32 v9, v9
    s_waitcnt vmcnt(7)
    s_cbranch_vccnz Lw_94
    s_waitcnt vmcnt(4)
Lw_94:
    buffer_load_dwordx4 v[224:227], v3, s[8:11], s21 offen offset:0 nt
    s_waitcnt lgkmcnt(0)
    v_cmp_eq_u32 vcc, 1, v9
    v_perm_b32 v16, v164, v160, s24
    v_perm_b32 v18, v164, v160, s25
    v_perm_b32 v20, v165, v161, s24
    v_perm_b32 v22, v165, v161, s25
    v_perm_b32 v24, v166, v162, s24
    v_perm_b32 v26, v166, v162, s25
    v_perm_b32 v28, v167, v163, s24
    v_perm_b32 v30, v167, v163, s25
    v_perm_b32 v17, v172, v168, s24
    v_perm_b32 v19, v172, v168, s25
    v_perm_b32 v21, v173, v169, s24
    v_perm_b32 v23, v173, v169, s25
    v_perm_b32 v25, v174, v170, s24
    v_perm_b32 v27, v174, v170, s25
    v_perm_b32 v29, v175, v171, s24
    v_perm_b32 v31, v175, v171, s25
    s_waitcnt vmcnt(7)
    s_cbranch_vccnz Lw_95
    s_waitcnt vmcnt(4)
Lw_95:
    buffer_load_dwordx4 v[228:231], v3, s[8:11], s21 offen offset:1024 nt
    v_mfma_f32_16x16x16_bf16 v[80:83], v[16:17], v[42:43], v[80:83]
    v_mfma_f32_16x16x16_bf16 v[84:87], v[18:19], v[42:43], v[84:87]
    v_mfma_f32_16x16x16_bf16 v[88:91], v[20:21], v[42:43], v[88:91]
    v_mfma_f32_16x16x16_bf16 v[92:95], v[22:23], v[42:43], v[92:95]
    v_mfma_f32_16x16x16_bf16 v[96:99], v[24:25], v[42:43], v[96:99]
    v_mfma_f32_16x16x16_bf16 v[100:103], v[26:27], v[42:43], v[100:103]
    v_mfma_f32_16x16x16_bf16 v[104:107], v[28:29], v[42:43], v[104:107]
    v_mfma_f32_16x16x16_bf16 v[108:111], v[30:31], v[42:43], v[108:111]
    s_waitcnt vmcnt(7)
    s_cbranch_vccnz Lw_96
    s_waitcnt vmcnt(4)
Lw_96:
    buffer_load_dwordx4 v[232:235], v3, s[8:11], s21 offen offset:2048 nt
    v_perm_b32 v16, v180, v176, s24
    v_perm_b32 v18, v180, v176, s25
    v_perm_b32 v20, v181, v177, s24
    v_perm_b32 v22, v181, v177, s25
    v_perm_b32 v24, v182, v178, s24
    v_perm_b32 v26, v182, v178, s25
    v_perm_b32 v28, v183, v179, s24
    v_perm_b32 v30, v183, v179, s25
    v_perm_b32 v17, v188, v184, s24
    v_perm_b32 v19, v188, v184, s25
    v_perm_b32 v21, v189, v185, s24
    v_perm_b32 v23, v189, v185, s25
    v_perm_b32 v25, v190, v186, s24
    v_perm_b32 v27, v190, v186, s25
    v_perm_b32 v29, v191, v187, s24
    v_perm_b32 v31, v191, v187, s25
    v_mov_b32 v9, 143024
    ds_read_b32 v9, v9
    s_waitcnt vmcnt(7)
    s_cbranch_vccnz Lw_97
    s_waitcnt vmcnt(4)
Lw_97:
    buffer_load_dwordx4 v[236:239], v3, s[8:11], s21 offen offset:3072 nt
    s_add_u32 s21, s21, 16384
    s_waitcnt lgkmcnt(0)
    v_cmp_eq_u32 vcc, 1, v9
    v_mfma_f32_16x16x16_bf16 v[80:83], v[16:17], v[44:45], v[80:83]
    v_mfma_f32_16x16x16_bf16 v[84:87], v[18:19], v[44:45], v[84:87]
    v_mfma_f32_16x16x16_bf16 v[88:91], v[20:21], v[44:45], v[88:91]
    v_mfma_f32_16x16x16_bf16 v[92:95], v[22:23], v[44:45], v[92:95]
    v_mfma_f32_16x16x16_bf16 v[96:99], v[24:25], v[44:45], v[96:99]
    v_mfma_f32_16x16x16_bf16 v[100:103], v[26:27], v[44:45], v[100:103]
    v_mfma_f32_16x16x16_bf16 v[104:107], v[28:29], v[44:45], v[104:107]
    v_mfma_f32_16x16x16_bf16 v[108:111], v[30:31], v[44:45], v[108:111]
    s_waitcnt vmcnt(7)
    s_cbranch_vccnz Lw_98
    s_waitcnt vmcnt(4)
Lw_98:
    buffer_load_dwordx4 v[48:51], v3, s[8:11], s21 offen offset:0 nt
    v_perm_b32 v16, v196, v192, s24
    v_perm_b32 v18, v196, v192, s25
    v_perm_b32 v20, v197, v193, s24
    v_perm_b32 v22, v197, v193, s25
    v_perm_b32 v24, v198, v194, s24
    v_perm_b32 v26, v198, v194, s25
    v_perm_b32 v28, v199, v195, s24
    v_perm_b32 v30, v199, v195, s25
    v_perm_b32 v17, v204, v200, s24
    v_perm_b32 v19, v204, v200, s25
    v_perm_b32 v21, v205, v201, s24
    v_perm_b32 v23, v205, v201, s25
    v_perm_b32 v25, v206, v202, s24
    v_perm_b32 v27, v206, v202, s25
    v_perm_b32 v29, v207, v203, s24
    v_perm_b32 v31, v207, v203, s25
    s_waitcnt vmcnt(7)
    s_cbranch_vccnz Lw_99
    s_waitcnt vmcnt(4)
Lw_99:
    buffer_load_dwordx4 v[52:55], v3, s[8:11], s21 offen offset:1024 nt
    v_mov_b32 v14, 13
    ds_write_b32 v15, v14
    v_mfma_f32_16x16x16_bf16 v[80:83], v[16:17], v[46:47], v[80:83]
    v_mfma_f32_16x16x16_bf16 v[84:87], v[18:19], v[46:47], v[84:87]
    v_mfma_f32_16x16x16_bf16 v[88:91], v[20:21], v[46:47], v[88:91]
    v_mfma_f32_16x16x16_bf16 v[92:95], v[22:23], v[46:47], v[92:95]
    v_mfma_f32_16x16x16_bf16 v[96:99], v[24:25], v[46:47], v[96:99]
    v_mfma_f32_16x16x16_bf16 v[100:103], v[26:27], v[46:47], v[100:103]
    v_mfma_f32_16x16x16_bf16 v[104:107], v[28:29], v[46:47], v[104:107]
    v_mfma_f32_16x16x16_bf16 v[108:111], v[30:31], v[46:47], v[108:111]
    v_mov_b32 v9, 143024
    ds_read_b32 v9, v9
    s_waitcnt vmcnt(7)
    s_cbranch_vccnz Lw_100
    s_waitcnt vmcnt(4)
Lw_100:
    buffer_load_dwordx4 v[56:59], v3, s[8:11], s21 offen offset:2048 nt
    s_waitcnt lgkmcnt(0)
    v_cmp_eq_u32 vcc, 1, v9
    s_waitcnt vmcnt(7)
    s_cbranch_vccnz Lw_101
    s_waitcnt vmcnt(4)
Lw_101:
    buffer_load_dwordx4 v[60:63], v3, s[8:11], s21 offen offset:3072 nt
    s_add_u32 s21, s21, 16384
    s_branch L_pad_kvl
.p2align 12
L_pad_kvl:
    v_perm_b32 v16, v212, v208, s24
    v_perm_b32 v18, v212, v208, s25
    v_perm_b32 v20, v213, v209, s24
    v_perm_b32 v22, v213, v209, s25
    v_perm_b32 v24, v214, v210, s24
    v_perm_b32 v26, v214, v210, s25
    v_perm_b32 v28, v215, v211, s24
    v_perm_b32 v30, v215, v211, s25
    v_perm_b32 v17, v220, v216, s24
    v_perm_b32 v19, v220, v216, s25
    v_perm_b32 v21, v221, v217, s24
    v_perm_b32 v23, v221, v217, s25
    v_perm_b32 v25, v222, v218, s24
    v_perm_b32 v27, v222, v218, s25
    v_perm_b32 v29, v223, v219, s24
    v_perm_b32 v31, v223, v219, s25
    s_waitcnt vmcnt(7)
    s_cbranch_vccnz Lw_102
    s_waitcnt vmcnt(4)
Lw_102:
    buffer_load_dwordx4 v[112:115], v3, s[8:11], s21 offen offset:0 nt
    v_mov_b32 v14, 14
    ds_write_b32 v15, v14
    v_mfma_f32_16x16x16_bf16 v[80:83], v[16:17], v[64:65], v[80:83]
    v_mfma_f32_16x16x16_bf16 v[84:87], v[18:19], v[64:65], v[84:87]
    v_mfma_f32_16x16x16_bf16 v[88:91], v[20:21], v[64:65], v[88:91]
    v_mfma_f32_16x16x16_bf16 v[92:95], v[22:23], v[64:65], v[92:95]
    v_mfma_f32_16x16x16_bf16 v[96:99], v[24:25], v[64:65], v[96:99]
    v_mfma_f32_16x16x16_bf16 v[100:103], v[26:27], v[64:65], v[100:103]
    v_mfma_f32_16x16x16_bf16 v[104:107], v[28:29], v[64:65], v[104:107]
    v_mfma_f32_16x16x16_bf16 v[108:111], v[30:31], v[64:65], v[108:111]
    v_mov_b32 v9, 143024
    ds_read_b32 v9, v9
    s_waitcnt vmcnt(7)
    s_cbranch_vccnz Lw_103
    s_waitcnt vmcnt(4)
Lw_103:
    buffer_load_dwordx4 v[116:119], v3, s[8:11], s21 offen offset:1024 nt
    s_waitcnt lgkmcnt(0)
    v_cmp_eq_u32 vcc, 1, v9
    s_waitcnt vmcnt(7)
    s_cbranch_vccnz Lw_104
    s_waitcnt vmcnt(4)
Lw_104:
    buffer_load_dwordx4 v[120:123], v3, s[8:11], s21 offen offset:2048 nt
    s_waitcnt vmcnt(7)
    s_cbranch_vccnz Lw_105
    s_waitcnt vmcnt(4)
Lw_105:
    buffer_load_dwordx4 v[124:127], v3, s[8:11], s21 offen offset:3072 nt
    s_add_u32 s21, s21, 16384
    v_perm_b32 v16, v228, v224, s24
    v_perm_b32 v18, v228, v224, s25
    v_perm_b32 v20, v229, v225, s24
    v_perm_b32 v22, v229, v225, s25
    v_perm_b32 v24, v230, v226, s24
    v_perm_b32 v26, v230, v226, s25
    v_perm_b32 v28, v231, v227, s24
    v_perm_b32 v30, v231, v227, s25
    v_perm_b32 v17, v236, v232, s24
    v_perm_b32 v19, v236, v232, s25
    v_perm_b32 v21, v237, v233, s24
    v_perm_b32 v23, v237, v233, s25
    v_perm_b32 v25, v238, v234, s24
    v_perm_b32 v27, v238, v234, s25
    v_perm_b32 v29, v239, v235, s24
    v_perm_b32 v31, v239, v235, s25
    v_mov_b32 v9, 143024
    ds_read_b32 v9, v9
    s_waitcnt vmcnt(7)
    s_cbranch_vccnz Lw_106
    s_waitcnt vmcnt(4)
Lw_106:
    buffer_load_dwordx4 v[128:131], v3, s[8:11], s21 offen offset:0 nt
    s_waitcnt lgkmcnt(0)
    v_cmp_eq_u32 vcc, 1, v9
    v_mfma_f32_16x16x16_bf16 v[80:83], v[16:17], v[66:67], v[80:83]
    v_mfma_f32_16x16x16_bf16 v[84:87], v[18:19], v[66:67], v[84:87]
    v_mfma_f32_16x16x16_bf16 v[88:91], v[20:21], v[66:67], v[88:91]
    v_mfma_f32_16x16x16_bf16 v[92:95], v[22:23], v[66:67], v[92:95]
    v_mfma_f32_16x16x16_bf16 v[96:99], v[24:25], v[66:67], v[96:99]
    v_mfma_f32_16x16x16_bf16 v[100:103], v[26:27], v[66:67], v[100:103]
    v_mfma_f32_16x16x16_bf16 v[104:107], v[28:29], v[66:67], v[104:107]
    v_mfma_f32_16x16x16_bf16 v[108:111], v[30:31], v[66:67], v[108:111]
    s_waitcnt vmcnt(7)
    s_cbranch_vccnz Lw_107
    s_waitcnt vmcnt(4)
Lw_107:
    buffer_load_dwordx4 v[132:135], v3, s[8:11], s21 offen offset:1024 nt
    s_waitcnt vmcnt(7)
    s_cbranch_vccnz Lw_108
    s_waitcnt vmcnt(4)
Lw_108:
    buffer_load_dwordx4 v[136:139], v3, s[8:11], s21 offen offset:2048 nt
    v_mov_b32 v9, 143024
    ds_read_b32 v9, v9
    s_waitcnt vmcnt(7)
    s_cbranch_vccnz Lw_109
    s_waitcnt vmcnt(4)
Lw_109:
    buffer_load_dwordx4 v[140:143], v3, s[8:11], s21 offen offset:3072 nt
    s_add_u32 s21, s21, 16384
    s_waitcnt lgkmcnt(0)
    v_cmp_eq_u32 vcc, 1, v9
    v_perm_b32 v16, v52, v48, s24
    v_perm_b32 v18, v52, v48, s25
    v_perm_b32 v20, v53, v49, s24
    v_perm_b32 v22, v53, v49, s25
    v_perm_b32 v24, v54, v50, s24
    v_perm_b32 v26, v54, v50, s25
    v_perm_b32 v28, v55, v51, s24
    v_perm_b32 v30, v55, v51, s25
    v_perm_b32 v17, v60, v56, s24
    v_perm_b32 v19, v60, v56, s25
    v_perm_b32 v21, v61, v57, s24
    v_perm_b32 v23, v61, v57, s25
    v_perm_b32 v25, v62, v58, s24
    v_perm_b32 v27, v62, v58, s25
    v_perm_b32 v29, v63, v59, s24
    v_perm_b32 v31, v63, v59, s25
    s_waitcnt vmcnt(7)
    s_cbranch_vccnz Lw_110
    s_waitcnt vmcnt(4)
Lw_110:
    buffer_load_dwordx4 v[144:147], v3, s[8:11], s21 offen offset:0 nt
    v_mfma_f32_16x16x16_bf16 v[80:83], v[16:17], v[68:69], v[80:83]
    v_mfma_f32_16x16x16_bf16 v[84:87], v[18:19], v[68:69], v[84:87]
    v_mfma_f32_16x16x16_bf16 v[88:91], v[20:21], v[68:69], v[88:91]
    v_mfma_f32_16x16x16_bf16 v[92:95], v[22:23], v[68:69], v[92:95]
    v_mfma_f32_16x16x16_bf16 v[96:99], v[24:25], v[68:69], v[96:99]
    v_mfma_f32_16x16x16_bf16 v[100:103], v[26:27], v[68:69], v[100:103]
    v_mfma_f32_16x16x16_bf16 v[104:107], v[28:29], v[68:69], v[104:107]
    v_mfma_f32_16x16x16_bf16 v[108:111], v[30:31], v[68:69], v[108:111]
    s_waitcnt vmcnt(7)
    s_cbranch_vccnz Lw_111
    s_waitcnt vmcnt(4)
Lw_111:
    buffer_load_dwordx4 v[148:151], v3, s[8:11], s21 offen offset:1024 nt
    v_mov_b32 v9, 143024
    ds_read_b32 v9, v9
    s_waitcnt vmcnt(7)
    s_cbranch_vccnz Lw_112
    s_waitcnt vmcnt(4)
Lw_112:
    buffer_load_dwordx4 v[152:155], v3, s[8:11], s21 offen offset:2048 nt
    v_mov_b32 v14, 15
    ds_write_b32 v15, v14
    s_waitcnt lgkmcnt(0)
    v_cmp_eq_u32 vcc, 1, v9
    s_waitcnt vmcnt(7)
    s_cbranch_vccnz Lw_113
    s_waitcnt vmcnt(4)
Lw_113:
    buffer_load_dwordx4 v[156:159], v3, s[8:11], s21 offen offset:3072 nt
    s_add_u32 s21, s21, 16384
    v_perm_b32 v16, v116, v112, s24
    v_perm_b32 v18, v116, v112, s25
    v_perm_b32 v20, v117, v113, s24
    v_perm_b32 v22, v117, v113, s25
    v_perm_b32 v24, v118, v114, s24
    v_perm_b32 v26, v118, v114, s25
    v_perm_b32 v28, v119, v115, s24
    v_perm_b32 v30, v119, v115, s25
    v_perm_b32 v17, v124, v120, s24
    v_perm_b32 v19, v124, v120, s25
    v_perm_b32 v21, v125, v121, s24
    v_perm_b32 v23, v125, v121, s25
    v_perm_b32 v25, v126, v122, s24
    v_perm_b32 v27, v126, v122, s25
    v_perm_b32 v29, v127, v123, s24
    v_perm_b32 v31, v127, v123, s25
    s_waitcnt vmcnt(7)
    s_cbranch_vccnz Lw_114
    s_waitcnt vmcnt(4)
Lw_114:
    buffer_load_dwordx4 v[160:163], v3, s[8:11], s21 offen offset:0 nt
    v_mfma_f32_16x16x16_bf16 v[80:83], v[16:17], v[70:71], v[80:83]
    v_mfma_f32_16x16x16_bf16 v[84:87], v[18:19], v[70:71], v[84:87]
    v_mfma_f32_16x16x16_bf16 v[88:91], v[20:21], v[70:71], v[88:91]
    v_mfma_f32_16x16x16_bf16 v[92:95], v[22:23], v[70:71], v[92:95]
    v_mfma_f32_16x16x16_bf16 v[96:99], v[24:25], v[70:71], v[96:99]
    v_mfma_f32_16x16x16_bf16 v[100:103], v[26:27], v[70:71], v[100:103]
    v_mfma_f32_16x16x16_bf16 v[104:107], v[28:29], v[70:71], v[104:107]
    v_mfma_f32_16x16x16_bf16 v[108:111], v[30:31], v[70:71], v[108:111]
    v_mov_b32 v9, 143024
    ds_read_b32 v9, v9
    s_waitcnt vmcnt(7)
    s_cbranch_vccnz Lw_115
    s_waitcnt vmcnt(4)
Lw_115:
    buffer_load_dwordx4 v[164:167], v3, s[8:11], s21 offen offset:1024 nt
    s_waitcnt lgkmcnt(0)
    v_cmp_eq_u32 vcc, 1, v9
    s_waitcnt vmcnt(7)
    s_cbranch_vccnz Lw_116
    s_waitcnt vmcnt(4)
Lw_116:
    buffer_load_dwordx4 v[168:171], v3, s[8:11], s21 offen offset:2048 nt
    s_waitcnt vmcnt(7)
    s_cbranch_vccnz Lw_117
    s_waitcnt vmcnt(4)
Lw_117:
    buffer_load_dwordx4 v[172:175], v3, s[8:11], s21 offen offset:3072 nt
    s_add_u32 s21, s21, 16384
    v_perm_b32 v16, v132, v128, s24
    v_perm_b32 v18, v132, v128, s25
    v_perm_b32 v20, v133, v129, s24
    v_perm_b32 v22, v133, v129, s25
    v_perm_b32 v24, v134, v130, s24
    v_perm_b32 v26, v134, v130, s25
    v_perm_b32 v28, v135, v131, s24
    v_perm_b32 v30, v135, v131, s25
    v_perm_b32 v17, v140, v136, s24
    v_perm_b32 v19, v140, v136, s25
    v_perm_b32 v21, v141, v137, s24
    v_perm_b32 v23, v141, v137, s25
    v_perm_b32 v25, v142, v138, s24
    v_perm_b32 v27, v142, v138, s25
    v_perm_b32 v29, v143, v139, s24
    v_perm_b32 v31, v143, v139, s25
    v_mov_b32 v9, 143024
    ds_read_b32 v9, v9
    s_waitcnt vmcnt(7)
    s_cbranch_vccnz Lw_118
    s_waitcnt vmcnt(4)
Lw_118:
    buffer_load_dwordx4 v[176:179], v3, s[8:11], s21 offen offset:0 nt
    s_waitcnt lgkmcnt(0)
    v_cmp_eq_u32 vcc, 1, v9
    v_mfma_f32_16x16x16_bf16 v[80:83], v[16:17], v[72:73], v[80:83]
    v_mfma_f32_16x16x16_bf16 v[84:87], v[18:19], v[72:73], v[84:87]
    v_mfma_f32_16x16x16_bf16 v[88:91], v[20:21], v[72:73], v[88:91]
    v_mfma_f32_16x16x16_bf16 v[92:95], v[22:23], v[72:73], v[92:95]
    v_mfma_f32_16x16x16_bf16 v[96:99], v[24:25], v[72:73], v[96:99]
    v_mfma_f32_16x16x16_bf16 v[100:103], v[26:27], v[72:73], v[100:103]
    v_mfma_f32_16x16x16_bf16 v[104:107], v[28:29], v[72:73], v[104:107]
    v_mfma_f32_16x16x16_bf16 v[108:111], v[30:31], v[72:73], v[108:111]
    s_waitcnt vmcnt(7)
    s_cbranch_vccnz Lw_119
    s_waitcnt vmcnt(4)
Lw_119:
    buffer_load_dwordx4 v[180:183], v3, s[8:11], s21 offen offset:1024 nt
    s_waitcnt vmcnt(7)
    s_cbranch_vccnz Lw_120
    s_waitcnt vmcnt(4)
Lw_120:
    buffer_load_dwordx4 v[184:187], v3, s[8:11], s21 offen offset:2048 nt
    v_mov_b32 v9, 143024
    ds_read_b32 v9, v9
    s_waitcnt vmcnt(7)
    s_cbranch_vccnz Lw_121
    s_waitcnt vmcnt(4)
Lw_121:
    buffer_load_dwordx4 v[188:191], v3, s[8:11], s21 offen offset:3072 nt
    s_add_u32 s21, s21, 16384
    s_waitcnt lgkmcnt(0)
    v_cmp_eq_u32 vcc, 1, v9
    v_perm_b32 v16, v148, v144, s24
    v_perm_b32 v18, v148, v144, s25
    v_perm_b32 v20, v149, v145, s24
    v_perm_b32 v22, v149, v145, s25
    v_perm_b32 v24, v150, v146, s24
    v_perm_b32 v26, v150, v146, s25
    v_perm_b32 v28, v151, v147, s24
    v_perm_b32 v30, v151, v147, s25
    v_perm_b32 v17, v156, v152, s24
    v_perm_b32 v19, v156, v152, s25
    v_perm_b32 v21, v157, v153, s24
    v_perm_b32 v23, v157, v153, s25
    v_perm_b32 v25, v158, v154, s24
    v_perm_b32 v27, v158, v154, s25
    v_perm_b32 v29, v159, v155, s24
    v_perm_b32 v31, v159, v155, s25
    s_bitcmp0_b32 s2, 0
    s_cselect_b32 s16, s48, s50
    s_cselect_b32 s17, s49, s51
    s_mov_b32 s18, 7340032
    s_mov_b32 s19, 0x20000
    v_mul_u32_u24 v14, 7168, v2
    s_mov_b32 s34, 8
    v_lshlrev_b32 v12, 1, v2
    v_xor_b32 v12, v12, v1
    v_xor_b32 v13, s34, v12
    v_lshl_add_u32 v12, v12, 4, v14
    v_lshl_add_u32 v13, v13, 4, v14
    s_lshr_b32 s35, s2, 3
    s_add_u32 s28, s35, 2
    s_mul_i32 s28, s28, 43
    s_lshr_b32 s28, s28, 7
    s_add_u32 s28, s28, s35
    s_lshl_b32 s35, s35, 2
    s_sub_u32 s35, s35, 79
    s_min_u32 s35, s35, 27
    s_cmp_lt_u32 s2, 160
    s_cselect_b32 s35, s28, s35
    s_bfe_u32 s28, s2, 131073
    s_lshl_b32 s28, s28, 2
    s_add_u32 s28, s28, s3
    s_mul_i32 s28, s28, 458752
    s_lshl_b32 s35, s35, 8
    s_add_u32 s28, s28, s35
    s_lshl_b32 s29, s3, 14
    s_add_u32 s29, s29, 0
    s_lshl_b32 s34, s3, 13
    s_add_u32 s34, s34, 102400
    s_cmp_ge_u32 s2, 160
    s_cselect_b32 s18, 0, s18
    s_cselect_b32 s29, s34, s29
    s_cselect_b32 s64, 0, 1024
    s_movk_i32 s65, 28672
    s_sub_u32 s34, s2, 160
    s_cmp_ge_u32 s34, 64
    s_cbranch_scc1 L_nohdn
    s_mov_b32 s16, s52
    s_mov_b32 s17, s53
    s_mov_b32 s18, 7340032
    s_mov_b32 s19, 0x20000
    v_lshlrev_b32 v14, 11, v2
    s_mov_b32 s34, 8
    v_lshlrev_b32 v12, 1, v2
    v_xor_b32 v12, v12, v1
    v_xor_b32 v13, s34, v12
    v_lshl_add_u32 v12, v12, 4, v14
    v_lshl_add_u32 v13, v13, 4, v14
    s_lshr_b32 s28, s2, 3
    s_add_u32 s35, s28, 2
    s_mul_i32 s35, s35, 43
    s_lshr_b32 s35, s35, 7
    s_add_u32 s35, s35, s28
    s_lshl_b32 s28, s28, 2
    s_sub_u32 s28, s28, 79
    s_min_u32 s28, s28, 27
    s_cmp_lt_u32 s2, 160
    s_cselect_b32 s28, s35, s28
    s_lshl_b32 s28, s28, 2
    s_add_u32 s28, s28, s3
    s_lshl_b32 s28, s28, 16
    s_and_b32 s35, s2, 7
    s_lshl_b32 s35, s35, 8
    s_add_u32 s28, s28, s35
    s_lshl_b32 s29, s3, 13
    s_add_u32 s29, s29, 65536
    s_movk_i32 s64, 1024
    s_movk_i32 s65, 8192
L_nohdn:
    s_cmp_lt_u32 s2, 224
    s_cbranch_scc1 L_nospw
    s_waitcnt vmcnt(0)
L_nospw:
    s_mov_b32 m0, s29
    s_add_u32 s29, s29, s64
    s_waitcnt vmcnt(7)
    s_cbranch_vccnz Lw_122
    s_waitcnt vmcnt(4)
Lw_122:
    buffer_load_dwordx4 v12, s[16:19], s28 offen nt lds
    s_add_u32 s28, s28, s65
    v_mfma_f32_16x16x16_bf16 v[80:83], v[16:17], v[74:75], v[80:83]
    v_mfma_f32_16x16x16_bf16 v[84:87], v[18:19], v[74:75], v[84:87]
    v_mfma_f32_16x16x16_bf16 v[88:91], v[20:21], v[74:75], v[88:91]
    v_mfma_f32_16x16x16_bf16 v[92:95], v[22:23], v[74:75], v[92:95]
    v_mfma_f32_16x16x16_bf16 v[96:99], v[24:25], v[74:75], v[96:99]
    v_mfma_f32_16x16x16_bf16 v[100:103], v[26:27], v[74:75], v[100:103]
    v_mfma_f32_16x16x16_bf16 v[104:107], v[28:29], v[74:75], v[104:107]
    v_mfma_f32_16x16x16_bf16 v[108:111], v[30:31], v[74:75], v[108:111]
    s_mov_b32 m0, s29
    s_add_u32 s29, s29, s64
    s_waitcnt vmcnt(7)
    s_cbranch_vccnz Lw_123
    s_waitcnt vmcnt(4)
Lw_123:
    buffer_load_dwordx4 v13, s[16:19], s28 offen nt lds
    s_add_u32 s28, s28, s65
    v_perm_b32 v16, v164, v160, s24
    v_perm_b32 v18, v164, v160, s25
    v_perm_b32 v20, v165, v161, s24
    v_perm_b32 v22, v165, v161, s25
    v_perm_b32 v24, v166, v162, s24
    v_perm_b32 v26, v166, v162, s25
    v_perm_b32 v28, v167, v163, s24
    v_perm_b32 v30, v167, v163, s25
    s_waitcnt vmcnt(6)
    v_perm_b32 v17, v172, v168, s24
    v_perm_b32 v19, v172, v168, s25
    v_perm_b32 v21, v173, v169, s24
    v_perm_b32 v23, v173, v169, s25
    v_perm_b32 v25, v174, v170, s24
    v_perm_b32 v27, v174, v170, s25
    v_perm_b32 v29, v175, v171, s24
    v_perm_b32 v31, v175, v171, s25
    v_mfma_f32_16x16x16_bf16 v[80:83], v[16:17], v[76:77], v[80:83]
    v_mfma_f32_16x16x16_bf16 v[84:87], v[18:19], v[76:77], v[84:87]
    v_mfma_f32_16x16x16_bf16 v[88:91], v[20:21], v[76:77], v[88:91]
    v_mfma_f32_16x16x16_bf16 v[92:95], v[22:23], v[76:77], v[92:95]
    v_mfma_f32_16x16x16_bf16 v[96:99], v[24:25], v[76:77], v[96:99]
    v_mfma_f32_16x16x16_bf16 v[100:103], v[26:27], v[76:77], v[100:103]
    v_mfma_f32_16x16x16_bf16 v[104:107], v[28:29], v[76:77], v[104:107]
    v_mfma_f32_16x16x16_bf16 v[108:111], v[30:31], v[76:77], v[108:111]
    s_mov_b32 m0, s29
    s_add_u32 s29, s29, s64
    s_cbranch_vccnz Lw_124
    s_waitcnt vmcnt(4)
Lw_124:
    buffer_load_dwordx4 v12, s[16:19], s28 offen nt lds
    s_add_u32 s28, s28, s65
    s_waitcnt vmcnt(5)
    v_perm_b32 v16, v180, v176, s24
    v_perm_b32 v18, v180, v176, s25
    v_perm_b32 v20, v181, v177, s24
    v_perm_b32 v22, v181, v177, s25
    v_perm_b32 v24, v182, v178, s24
    v_perm_b32 v26, v182, v178, s25
    v_perm_b32 v28, v183, v179, s24
    v_perm_b32 v30, v183, v179, s25
    s_waitcnt vmcnt(3)
    v_perm_b32 v17, v188, v184, s24
    v_perm_b32 v19, v188, v184, s25
    v_perm_b32 v21, v189, v185, s24
    v_perm_b32 v23, v189, v185, s25
    v_perm_b32 v25, v190, v186, s24
    v_perm_b32 v27, v190, v186, s25
    v_perm_b32 v29, v191, v187, s24
    v_perm_b32 v31, v191, v187, s25
    v_mfma_f32_16x16x16_bf16 v[80:83], v[16:17], v[78:79], v[80:83]
    v_mfma_f32_16x16x16_bf16 v[84:87], v[18:19], v[78:79], v[84:87]
    v_mfma_f32_16x16x16_bf16 v[88:91], v[20:21], v[78:79], v[88:91]
    v_mfma_f32_16x16x16_bf16 v[92:95], v[22:23], v[78:79], v[92:95]
    v_mfma_f32_16x16x16_bf16 v[96:99], v[24:25], v[78:79], v[96:99]
    v_mfma_f32_16x16x16_bf16 v[100:103], v[26:27], v[78:79], v[100:103]
    v_mfma_f32_16x16x16_bf16 v[104:107], v[28:29], v[78:79], v[104:107]
    v_mfma_f32_16x16x16_bf16 v[108:111], v[30:31], v[78:79], v[108:111]
    s_mov_b32 exec_lo, 0x00ff00ff
    s_mov_b32 exec_hi, 0x00ff00ff
    ds_write_b128 v240, v[80:83] offset:0
    ds_write_b128 v241, v[84:87] offset:256
    ds_write_b128 v242, v[88:91] offset:512
    ds_write_b128 v243, v[92:95] offset:768
    ds_write_b128 v240, v[96:99] offset:128
    ds_write_b128 v241, v[100:103] offset:384
    ds_write_b128 v242, v[104:107] offset:640
    ds_write_b128 v243, v[108:111] offset:896
    s_mov_b64 exec, -1
    s_waitcnt lgkmcnt(0)
    s_barrier
    s_cmp_ge_u32 s2, 224
    s_cbranch_scc1 L_kvend
    s_cmp_lt_u32 s2, 160
    s_cbranch_scc1 Lh_125
    v_mov_b32 v14, 16
    ds_write_b32 v15, v14
Lh_125:
    s_cmp_ge_u32 s2, 160
    s_cselect_b32 s34, 3, 1
    v_mov_b32 v10, 143008
    s_mov_b32 s33, 2000000
Ltr_126:
    ds_read_b128 v[32:35], v10
    s_waitcnt lgkmcnt(0)
    v_min3_u32 v32, v32, v33, v34
    v_min_u32 v32, v32, v35
    v_cmp_gt_u32 vcc, s34, v32
    s_cbranch_vccz Ltd_127
    s_sub_u32 s33, s33, 1
    s_cbranch_scc1 Ltd_127
    s_sleep 1
    s_branch Ltr_126
Ltd_127:
    s_cmp_ge_u32 s2, 160
    s_cbranch_scc1 L_dn
    s_mov_b32 m0, s29
    s_add_u32 s29, s29, s64
    buffer_load_dwordx4 v13, s[16:19], s28 offen nt lds
    s_add_u32 s28, s28, 28672
    s_mov_b32 m0, s29
    s_add_u32 s29, s29, s64
    buffer_load_dwordx4 v12, s[16:19], s28 offen nt lds
    s_add_u32 s28, s28, 28672
    s_mov_b32 m0, s29
    s_add_u32 s29, s29, s64
    buffer_load_dwordx4 v13, s[16:19], s28 offen nt lds
    s_add_u32 s28, s28, 28672
    s_mov_b32 m0, s29
    s_add_u32 s29, s29, s64
    buffer_load_dwordx4 v12, s[16:19], s28 offen nt lds
    s_add_u32 s28, s28, 28672
    s_mov_b32 m0, s29
    s_add_u32 s29, s29, s64
    buffer_load_dwordx4 v13, s[16:19], s28 offen nt lds
    s_add_u32 s28, s28, 28672
    s_mov_b32 m0, s29
    s_add_u32 s29, s29, s64
    buffer_load_dwordx4 v12, s[16:19], s28 offen nt lds
    s_add_u32 s28, s28, 28672
    s_mov_b32 m0, s29
    s_add_u32 s29, s29, s64
    buffer_load_dwordx4 v13, s[16:19], s28 offen nt lds
    s_add_u32 s28, s28, 28672
    s_mov_b32 m0, s29
    s_add_u32 s29, s29, s64
    buffer_load_dwordx4 v12, s[16:19], s28 offen nt lds
    s_add_u32 s28, s28, 28672
    s_mov_b32 m0, s29
    s_add_u32 s29, s29, s64
    s_waitcnt vmcnt(10)
    buffer_load_dwordx4 v13, s[16:19], s28 offen nt lds
    s_add_u32 s28, s28, 28672
    s_mov_b32 m0, s29
    s_add_u32 s29, s29, s64
    s_waitcnt vmcnt(10)
    buffer_load_dwordx4 v12, s[16:19], s28 offen nt lds
    s_add_u32 s28, s28, 28672
    s_mov_b32 m0, s29
    s_add_u32 s29, s29, s64
    s_waitcnt vmcnt(10)
    buffer_load_dwordx4 v13, s[16:19], s28 offen nt lds
    s_add_u32 s28, s28, 28672
    s_mov_b32 m0, s29
    s_add_u32 s29, s29, s64
    s_waitcnt vmcnt(10)
    buffer_load_dwordx4 v12, s[16:19], s28 offen nt lds
    s_add_u32 s28, s28, 28672
    s_mov_b32 m0, s29
    s_add_u32 s29, s29, s64
    s_waitcnt vmcnt(10)
    buffer_load_dwordx4 v13, s[16:19], s28 offen nt lds
    s_add_u32 s28, s28, 28672
    s_movk_i32 s64, 1024
    s_mov_b32 s16, s52
    s_mov_b32 s17, s53
    s_mov_b32 s18, 7340032
    s_mov_b32 s19, 0x20000
    v_lshlrev_b32 v14, 11, v2
    s_mov_b32 s34, 8
    v_lshlrev_b32 v12, 1, v2
    v_xor_b32 v12, v12, v1
    v_xor_b32 v13, s34, v12
    v_lshl_add_u32 v12, v12, 4, v14
    v_lshl_add_u32 v13, v13, 4, v14
    s_lshr_b32 s28, s2, 3
    s_add_u32 s35, s28, 2
    s_mul_i32 s35, s35, 43
    s_lshr_b32 s35, s35, 7
    s_add_u32 s35, s35, s28
    s_lshl_b32 s28, s28, 2
    s_sub_u32 s28, s28, 79
    s_min_u32 s28, s28, 27
    s_cmp_lt_u32 s2, 160
    s_cselect_b32 s28, s35, s28
    s_lshl_b32 s28, s28, 2
    s_add_u32 s28, s28, s3
    s_lshl_b32 s28, s28, 16
    s_and_b32 s35, s2, 7
    s_lshl_b32 s35, s35, 8
    s_add_u32 s28, s28, s35
    s_lshl_b32 s29, s3, 13
    s_add_u32 s29, s29, 65536
    s_mov_b32 m0, s29
    s_add_u32 s29, s29, s64
    s_waitcnt vmcnt(10)
    buffer_load_dwordx4 v12, s[16:19], s28 offen nt lds
    s_add_u32 s28, s28, 8192
    s_mov_b32 m0, s29
    s_add_u32 s29, s29, s64
    s_waitcnt vmcnt(10)
    buffer_load_dwordx4 v13, s[16:19], s28 offen nt lds
    s_add_u32 s28, s28, 8192
    s_mov_b32 m0, s29
    s_add_u32 s29, s29, s64
    s_waitcnt vmcnt(10)
    buffer_load_dwordx4 v12, s[16:19], s28 offen nt lds
    s_add_u32 s28, s28, 8192
L_dn:
    s_mov_b32 m0, s29
    s_add_u32 s29, s29, s64
    s_waitcnt vmcnt(10)
    buffer_load_dwordx4 v13, s[16:19], s28 offen nt lds
    s_add_u32 s28, s28, 8192
    s_mov_b32 m0, s29
    s_add_u32 s29, s29, s64
    s_waitcnt vmcnt(10)
    buffer_load_dwordx4 v12, s[16:19], s28 offen nt lds
    s_add_u32 s28, s28, 8192
    s_mov_b32 m0, s29
    s_add_u32 s29, s29, s64
    s_waitcnt vmcnt(10)
    buffer_load_dwordx4 v13, s[16:19], s28 offen nt lds
    s_add_u32 s28, s28, 8192
    s_mov_b32 m0, s29
    s_add_u32 s29, s29, s64
    s_waitcnt vmcnt(10)
    buffer_load_dwordx4 v12, s[16:19], s28 offen nt lds
    s_add_u32 s28, s28, 8192
    s_mov_b32 m0, s29
    s_add_u32 s29, s29, s64
    s_waitcnt vmcnt(10)
    buffer_load_dwordx4 v13, s[16:19], s28 offen nt lds
    s_add_u32 s28, s28, 8192
    s_waitcnt vmcnt(8)
    v_mov_b32 v14, 16
    ds_write_b32 v15, v14
    s_waitcnt vmcnt(0)
L_kvend:
    v_mov_b32 v14, 17
    ds_write_b32 v15, v14
    s_waitcnt lgkmcnt(0)
    s_endpgm
L_gemv:
    s_setprio 1
    s_sub_u32 s30, s3, 4
    s_mov_b32 s31, 0
    v_lshlrev_b32 v16, 3, v0
    v_and_b32 v17, 0xff, v16
    s_lshl_b32 s28, s30, 11
    s_lshl_b32 s24, s2, 2
    s_add_u32 s24, s24, s30
    s_mul_i32 s24, s24, 1344
    v_mov_b32 v100, -1
    v_mov_b32 v101, -1
    v_mov_b32 v102, -1
    v_mov_b32 v103, -1
    v_mov_b32 v72, 0
    v_mov_b32 v73, 0
    v_mov_b32 v74, 0
    v_mov_b32 v75, 0
    v_and_b32 v14, 48, v3
    v_add_u32 v14, 142976, v14
    ds_write_b128 v14, v[72:75]
    s_waitcnt lgkmcnt(0)
    s_and_b32 s69, s2, 7
    s_lshl_b32 s69, s69, 1
    s_bfe_u32 s68, s2, 0x10003
    s_add_u32 s69, s69, s68
    s_lshl_b32 s69, s69, 4
    s_lshr_b32 s68, s2, 4
    s_add_u32 s69, s69, s68
    s_mov_b32 s12, s62
    s_mov_b32 s13, s63
    s_mov_b32 s14, 1376256
    s_mov_b32 s15, 0x20000
    s_cmp_lt_u32 s2, 96
    s_cselect_b32 s8, s54, s36
    s_cselect_b32 s9, s55, s37
    s_movk_i32 s10, 8192
    s_mov_b32 s11, 0x20000
    buffer_load_dwordx2 v[56:57], v16, s[8:11], s28 offen offset:0
    buffer_load_dwordx2 v[58:59], v16, s[8:11], s28 offen offset:512
    buffer_load_dwordx2 v[60:61], v16, s[8:11], s28 offen offset:1024
    buffer_load_dwordx2 v[62:63], v16, s[8:11], s28 offen offset:1536
    buffer_store_dwordx4 v[100:103], v3, s[12:15], s24 offen sc1
    s_mov_b64 exec, 0xfffff
    buffer_store_dwordx4 v[100:103], v3, s[12:15], s24 offen offset:1024 sc1
    s_mov_b64 exec, -1
    s_barrier
    v_lshrrev_b32 v15, 5, v0
    v_lshlrev_b32 v15, 4, v15
    v_lshl_add_u32 v15, v17, 3, v15
    s_mul_i32 s24, s30, 2112
    s_add_u32 s24, s24, 131072
    v_add_u32 v15, s24, v15
    s_waitcnt vmcnt(0)
    v_lshlrev_b32 v72, 16, v56
    v_and_b32 v73, 0xffff0000, v56
    v_lshlrev_b32 v74, 16, v57
    v_and_b32 v75, 0xffff0000, v57
    v_lshlrev_b32 v76, 16, v58
    v_and_b32 v77, 0xffff0000, v58
    v_lshlrev_b32 v78, 16, v59
    v_and_b32 v79, 0xffff0000, v59
    v_lshlrev_b32 v80, 16, v60
    v_and_b32 v81, 0xffff0000, v60
    v_lshlrev_b32 v82, 16, v61
    v_and_b32 v83, 0xffff0000, v61
    v_lshlrev_b32 v84, 16, v62
    v_and_b32 v85, 0xffff0000, v62
    v_lshlrev_b32 v86, 16, v63
    v_and_b32 v87, 0xffff0000, v63
    s_cmp_ge_u32 s2, 96
    s_cbranch_scc1 L_nosilu
    s_mov_b32 s24, 0xbfb8aa3b
    v_mul_f32 v40, s24, v72
    v_mul_f32 v41, s24, v73
    v_mul_f32 v42, s24, v74
    v_mul_f32 v43, s24, v75
    v_mul_f32 v44, s24, v76
    v_mul_f32 v45, s24, v77
    v_mul_f32 v46, s24, v78
    v_mul_f32 v47, s24, v79
    v_mul_f32 v48, s24, v80
    v_mul_f32 v49, s24, v81
    v_mul_f32 v50, s24, v82
    v_mul_f32 v51, s24, v83
    v_mul_f32 v52, s24, v84
    v_mul_f32 v53, s24, v85
    v_mul_f32 v54, s24, v86
    v_mul_f32 v55, s24, v87
    v_exp_f32 v40, v40
    v_exp_f32 v41, v41
    v_exp_f32 v42, v42
    v_exp_f32 v43, v43
    v_exp_f32 v44, v44
    v_exp_f32 v45, v45
    v_exp_f32 v46, v46
    v_exp_f32 v47, v47
    v_exp_f32 v48, v48
    v_exp_f32 v49, v49
    v_exp_f32 v50, v50
    v_exp_f32 v51, v51
    v_exp_f32 v52, v52
    v_exp_f32 v53, v53
    v_exp_f32 v54, v54
    v_exp_f32 v55, v55
    v_min_f32 v40, 0x7149f2ca, v40
    v_min_f32 v41, 0x7149f2ca, v41
    v_min_f32 v42, 0x7149f2ca, v42
    v_min_f32 v43, 0x7149f2ca, v43
    v_min_f32 v44, 0x7149f2ca, v44
    v_min_f32 v45, 0x7149f2ca, v45
    v_min_f32 v46, 0x7149f2ca, v46
    v_min_f32 v47, 0x7149f2ca, v47
    v_min_f32 v48, 0x7149f2ca, v48
    v_min_f32 v49, 0x7149f2ca, v49
    v_min_f32 v50, 0x7149f2ca, v50
    v_min_f32 v51, 0x7149f2ca, v51
    v_min_f32 v52, 0x7149f2ca, v52
    v_min_f32 v53, 0x7149f2ca, v53
    v_min_f32 v54, 0x7149f2ca, v54
    v_min_f32 v55, 0x7149f2ca, v55
    v_add_f32 v40, 1.0, v40
    v_add_f32 v41, 1.0, v41
    v_add_f32 v42, 1.0, v42
    v_add_f32 v43, 1.0, v43
    v_add_f32 v44, 1.0, v44
    v_add_f32 v45, 1.0, v45
    v_add_f32 v46, 1.0, v46
    v_add_f32 v47, 1.0, v47
    v_add_f32 v48, 1.0, v48
    v_add_f32 v49, 1.0, v49
    v_add_f32 v50, 1.0, v50
    v_add_f32 v51, 1.0, v51
    v_add_f32 v52, 1.0, v52
    v_add_f32 v53, 1.0, v53
    v_add_f32 v54, 1.0, v54
    v_add_f32 v55, 1.0, v55
    v_rcp_f32 v56, v40
    v_rcp_f32 v57, v41
    v_rcp_f32 v58, v42
    v_rcp_f32 v59, v43
    v_rcp_f32 v60, v44
    v_rcp_f32 v61, v45
    v_rcp_f32 v62, v46
    v_rcp_f32 v63, v47
    v_rcp_f32 v64, v48
    v_rcp_f32 v65, v49
    v_rcp_f32 v66, v50
    v_rcp_f32 v67, v51
    v_rcp_f32 v68, v52
    v_rcp_f32 v69, v53
    v_rcp_f32 v70, v54
    v_rcp_f32 v71, v55
    v_mul_f32 v6, v72, v56
    v_fma_f32 v72, -v6, v40, v72
    v_fma_f32 v72, v72, v56, v6
    v_mul_f32 v7, v73, v57
    v_fma_f32 v73, -v7, v41, v73
    v_fma_f32 v73, v73, v57, v7
    v_mul_f32 v8, v74, v58
    v_fma_f32 v74, -v8, v42, v74
    v_fma_f32 v74, v74, v58, v8
    v_mul_f32 v9, v75, v59
    v_fma_f32 v75, -v9, v43, v75
    v_fma_f32 v75, v75, v59, v9
    v_mul_f32 v6, v76, v60
    v_fma_f32 v76, -v6, v44, v76
    v_fma_f32 v76, v76, v60, v6
    v_mul_f32 v7, v77, v61
    v_fma_f32 v77, -v7, v45, v77
    v_fma_f32 v77, v77, v61, v7
    v_mul_f32 v8, v78, v62
    v_fma_f32 v78, -v8, v46, v78
    v_fma_f32 v78, v78, v62, v8
    v_mul_f32 v9, v79, v63
    v_fma_f32 v79, -v9, v47, v79
    v_fma_f32 v79, v79, v63, v9
    v_mul_f32 v6, v80, v64
    v_fma_f32 v80, -v6, v48, v80
    v_fma_f32 v80, v80, v64, v6
    v_mul_f32 v7, v81, v65
    v_fma_f32 v81, -v7, v49, v81
    v_fma_f32 v81, v81, v65, v7
    v_mul_f32 v8, v82, v66
    v_fma_f32 v82, -v8, v50, v82
    v_fma_f32 v82, v82, v66, v8
    v_mul_f32 v9, v83, v67
    v_fma_f32 v83, -v9, v51, v83
    v_fma_f32 v83, v83, v67, v9
    v_mul_f32 v6, v84, v68
    v_fma_f32 v84, -v6, v52, v84
    v_fma_f32 v84, v84, v68, v6
    v_mul_f32 v7, v85, v69
    v_fma_f32 v85, -v7, v53, v85
    v_fma_f32 v85, v85, v69, v7
    v_mul_f32 v8, v86, v70
    v_fma_f32 v86, -v8, v54, v86
    v_fma_f32 v86, v86, v70, v8
    v_mul_f32 v9, v87, v71
    v_fma_f32 v87, -v9, v55, v87
    v_fma_f32 v87, v87, v71, v9
    v_cvt_pk_bf16_f32 v40, v72, v73
    v_cvt_pk_bf16_f32 v41, v74, v75
    v_cvt_pk_bf16_f32 v42, v76, v77
    v_cvt_pk_bf16_f32 v43, v78, v79
    v_cvt_pk_bf16_f32 v44, v80, v81
    v_cvt_pk_bf16_f32 v45, v82, v83
    v_cvt_pk_bf16_f32 v46, v84, v85
    v_cvt_pk_bf16_f32 v47, v86, v87
    ds_write_b64 v15, v[40:41] offset:0
    ds_write_b64 v15, v[42:43] offset:32
    ds_write_b64 v15, v[44:45] offset:8
    ds_write_b64 v15, v[46:47] offset:40
L_nosilu:
    s_add_u32 s31, s31, 4
    s_waitcnt lgkmcnt(0)
    v_mov_b32 v39, 142976
    v_mov_b32 v4, 1
    s_mov_b64 exec, 1
    ds_add_u32 v39, v4
    s_mov_b64 exec, -1
    v_mov_b32 v39, 142976
    s_mov_b32 s33, 2000000
Lsp_128:
    ds_read_b32 v4, v39
    s_waitcnt lgkmcnt(0)
    v_readfirstlane_b32 s32, v4
    s_nop 0
    s_cmp_ge_u32 s32, s31
    s_cbranch_scc1 Lsd_129
    s_sub_u32 s33, s33, 1
    s_cbranch_scc1 Lsd_129
    s_sleep 1
    s_branch Lsp_128
Lsd_129:
    s_cmp_lg_u32 s30, 0
    s_cbranch_scc1 L_nocnt
    s_getreg_b32 s25, hwreg(HW_REG_XCC_ID, 0, 3)
    s_lshl_b32 s25, s25, 3
    s_lshl_b64 s[24:25], 1, s25
    s_and_b32 s26, s2, 7
    s_mul_i32 s26, s26, 32
    s_add_u32 s26, s60, s26
    s_addc_u32 s27, s61, 0
    s_atomic_add_x2 s[24:25], s[26:27], 0
    s_waitcnt lgkmcnt(0)
L_nocnt:
    s_cmp_ge_u32 s2, 160
    s_cbranch_scc1 L_rwo
    s_cmp_lt_u32 s2, 96
    s_cbranch_scc1 L_pre
    v_add_f32 v11, v72, v73
    v_add_f32 v11, v11, v74
    v_add_f32 v11, v11, v75
    v_add_f32 v11, v11, v76
    v_add_f32 v11, v11, v77
    v_add_f32 v11, v11, v78
    v_add_f32 v11, v11, v79
    v_add_f32 v11, v11, v80
    v_add_f32 v11, v11, v81
    v_add_f32 v11, v11, v82
    v_add_f32 v11, v11, v83
    v_add_f32 v11, v11, v84
    v_add_f32 v11, v11, v85
    v_add_f32 v11, v11, v86
    v_add_f32 v11, v11, v87
    s_nop 1
    v_add_f32_dpp v11, v11, v11 quad_perm:[1,0,3,2] row_mask:0xf bank_mask:0xf
    s_nop 1
    v_add_f32_dpp v11, v11, v11 quad_perm:[2,3,0,1] row_mask:0xf bank_mask:0xf
    s_nop 1
    v_add_f32_dpp v11, v11, v11 row_ror:4 row_mask:0xf bank_mask:0xf
    s_nop 1
    v_add_f32_dpp v11, v11, v11 row_ror:8 row_mask:0xf bank_mask:0xf
    v_mov_b32 v6, v11
    s_nop 1
    v_permlane32_swap_b32 v11, v6
    v_add_f32 v11, v11, v6
    v_mov_b32 v6, v11
    s_nop 1
    v_permlane16_swap_b32 v11, v6
    v_add_f32 v11, v11, v6
    v_mul_f32 v11, 0x3a800000, v11
    v_mov_b32 v12, 0
    v_sub_f32 v6, v72, v11
    v_fmac_f32 v12, v6, v6
    v_sub_f32 v6, v73, v11
    v_fmac_f32 v12, v6, v6
    v_sub_f32 v6, v74, v11
    v_fmac_f32 v12, v6, v6
    v_sub_f32 v6, v75, v11
    v_fmac_f32 v12, v6, v6
    v_sub_f32 v6, v76, v11
    v_fmac_f32 v12, v6, v6
    v_sub_f32 v6, v77, v11
    v_fmac_f32 v12, v6, v6
    v_sub_f32 v6, v78, v11
    v_fmac_f32 v12, v6, v6
    v_sub_f32 v6, v79, v11
    v_fmac_f32 v12, v6, v6
    v_sub_f32 v6, v80, v11
    v_fmac_f32 v12, v6, v6
    v_sub_f32 v6, v81, v11
    v_fmac_f32 v12, v6, v6
    v_sub_f32 v6, v82, v11
    v_fmac_f32 v12, v6, v6
    v_sub_f32 v6, v83, v11
    v_fmac_f32 v12, v6, v6
    v_sub_f32 v6, v84, v11
    v_fmac_f32 v12, v6, v6
    v_sub_f32 v6, v85, v11
    v_fmac_f32 v12, v6, v6
    v_sub_f32 v6, v86, v11
    v_fmac_f32 v12, v6, v6
    v_sub_f32 v6, v87, v11
    v_fmac_f32 v12, v6, v6
    s_nop 1
    v_add_f32_dpp v12, v12, v12 quad_perm:[1,0,3,2] row_mask:0xf bank_mask:0xf
    s_nop 1
    v_add_f32_dpp v12, v12, v12 quad_perm:[2,3,0,1] row_mask:0xf bank_mask:0xf
    s_nop 1
    v_add_f32_dpp v12, v12, v12 row_ror:4 row_mask:0xf bank_mask:0xf
    s_nop 1
    v_add_f32_dpp v12, v12, v12 row_ror:8 row_mask:0xf bank_mask:0xf
    v_mov_b32 v6, v12
    s_nop 1
    v_permlane32_swap_b32 v12, v6
    v_add_f32 v12, v12, v6
    v_mov_b32 v6, v12
    s_nop 1
    v_permlane16_swap_b32 v12, v6
    v_add_f32 v12, v12, v6
    v_mul_f32 v12, 0x3a800000, v12
    v_cvt_pk_bf16_f32 v11, 0, v11
    v_cvt_pk_bf16_f32 v12, 0, v12
    v_add_f32 v12, 0x3727c5ac, v12
    v_cvt_pk_bf16_f32 v12, 0, v12
    v_sqrt_f32 v12, v12
    s_nop 0
    v_cvt_pk_bf16_f32 v12, 0, v12
    v_rcp_f32 v13, v12
    v_sub_f32 v72, v72, v11
    v_sub_f32 v73, v73, v11
    v_sub_f32 v74, v74, v11
    v_sub_f32 v75, v75, v11
    v_sub_f32 v76, v76, v11
    v_sub_f32 v77, v77, v11
    v_sub_f32 v78, v78, v11
    v_sub_f32 v79, v79, v11
    v_sub_f32 v80, v80, v11
    v_sub_f32 v81, v81, v11
    v_sub_f32 v82, v82, v11
    v_sub_f32 v83, v83, v11
    v_sub_f32 v84, v84, v11
    v_sub_f32 v85, v85, v11
    v_sub_f32 v86, v86, v11
    v_sub_f32 v87, v87, v11
    v_cvt_pk_bf16_f32 v72, 0, v72
    v_cvt_pk_bf16_f32 v73, 0, v73
    v_cvt_pk_bf16_f32 v74, 0, v74
    v_cvt_pk_bf16_f32 v75, 0, v75
    v_cvt_pk_bf16_f32 v76, 0, v76
    v_cvt_pk_bf16_f32 v77, 0, v77
    v_cvt_pk_bf16_f32 v78, 0, v78
    v_cvt_pk_bf16_f32 v79, 0, v79
    v_cvt_pk_bf16_f32 v80, 0, v80
    v_cvt_pk_bf16_f32 v81, 0, v81
    v_cvt_pk_bf16_f32 v82, 0, v82
    v_cvt_pk_bf16_f32 v83, 0, v83
    v_cvt_pk_bf16_f32 v84, 0, v84
    v_cvt_pk_bf16_f32 v85, 0, v85
    v_cvt_pk_bf16_f32 v86, 0, v86
    v_cvt_pk_bf16_f32 v87, 0, v87
    v_mul_f32 v6, v72, v13
    v_fma_f32 v72, -v6, v12, v72
    v_fma_f32 v72, v72, v13, v6
    v_mul_f32 v7, v73, v13
    v_fma_f32 v73, -v7, v12, v73
    v_fma_f32 v73, v73, v13, v7
    v_mul_f32 v8, v74, v13
    v_fma_f32 v74, -v8, v12, v74
    v_fma_f32 v74, v74, v13, v8
    v_mul_f32 v9, v75, v13
    v_fma_f32 v75, -v9, v12, v75
    v_fma_f32 v75, v75, v13, v9
    v_mul_f32 v6, v76, v13
    v_fma_f32 v76, -v6, v12, v76
    v_fma_f32 v76, v76, v13, v6
    v_mul_f32 v7, v77, v13
    v_fma_f32 v77, -v7, v12, v77
    v_fma_f32 v77, v77, v13, v7
    v_mul_f32 v8, v78, v13
    v_fma_f32 v78, -v8, v12, v78
    v_fma_f32 v78, v78, v13, v8
    v_mul_f32 v9, v79, v13
    v_fma_f32 v79, -v9, v12, v79
    v_fma_f32 v79, v79, v13, v9
    v_mul_f32 v6, v80, v13
    v_fma_f32 v80, -v6, v12, v80
    v_fma_f32 v80, v80, v13, v6
    v_mul_f32 v7, v81, v13
    v_fma_f32 v81, -v7, v12, v81
    v_fma_f32 v81, v81, v13, v7
    v_mul_f32 v8, v82, v13
    v_fma_f32 v82, -v8, v12, v82
    v_fma_f32 v82, v82, v13, v8
    v_mul_f32 v9, v83, v13
    v_fma_f32 v83, -v9, v12, v83
    v_fma_f32 v83, v83, v13, v9
    v_mul_f32 v6, v84, v13
    v_fma_f32 v84, -v6, v12, v84
    v_fma_f32 v84, v84, v13, v6
    v_mul_f32 v7, v85, v13
    v_fma_f32 v85, -v7, v12, v85
    v_fma_f32 v85, v85, v13, v7
    v_mul_f32 v8, v86, v13
    v_fma_f32 v86, -v8, v12, v86
    v_fma_f32 v86, v86, v13, v8
    v_mul_f32 v9, v87, v13
    v_fma_f32 v87, -v9, v12, v87
    v_fma_f32 v87, v87, v13, v9
    v_cvt_pk_bf16_f32 v72, 0, v72
    v_cvt_pk_bf16_f32 v73, 0, v73
    v_cvt_pk_bf16_f32 v74, 0, v74
    v_cvt_pk_bf16_f32 v75, 0, v75
    v_cvt_pk_bf16_f32 v76, 0, v76
    v_cvt_pk_bf16_f32 v77, 0, v77
    v_cvt_pk_bf16_f32 v78, 0, v78
    v_cvt_pk_bf16_f32 v79, 0, v79
    v_cvt_pk_bf16_f32 v80, 0, v80
    v_cvt_pk_bf16_f32 v81, 0, v81
    v_cvt_pk_bf16_f32 v82, 0, v82
    v_cvt_pk_bf16_f32 v83, 0, v83
    v_cvt_pk_bf16_f32 v84, 0, v84
    v_cvt_pk_bf16_f32 v85, 0, v85
    v_cvt_pk_bf16_f32 v86, 0, v86
    v_cvt_pk_bf16_f32 v87, 0, v87
L_pre:
    v_lshrrev_b32 v6, 2, v1
    v_lshl_add_u32 v14, v6, 3, v2
    v_xor_b32 v6, s30, v6
    v_lshlrev_b32 v6, 5, v6
    v_lshl_add_u32 v14, v14, 7, v6
    v_and_b32 v6, 3, v1
    v_lshl_add_u32 v18, v6, 3, v14
    v_add_u32 v19, 65536, v18
    v_and_b32 v14, 3, v1
    v_mul_u32_u24 v14, 2112, v14
    v_lshl_add_u32 v14, v2, 4, v14
    v_add_u32 v20, 131072, v14
    ds_read_b128 v[40:43], v20 offset:0
    ds_read_b128 v[44:47], v20 offset:64
    ds_read_b128 v[48:51], v20 offset:128
    ds_read_b128 v[52:55], v20 offset:192
    ds_read_b128 v[56:59], v20 offset:256
    ds_read_b128 v[60:63], v20 offset:320
    ds_read_b128 v[64:67], v20 offset:384
    ds_read_b128 v[68:71], v20 offset:448
    v_mov_b32 v39, 142992
    s_mov_b32 s33, 2000000
Lms_130:
    ds_read_b128 v[124:127], v39
    s_waitcnt lgkmcnt(0)
    v_min3_u32 v124, v124, v125, v126
    v_min_u32 v124, v124, v127
    s_nop 0
    v_readfirstlane_b32 s32, v124
    s_nop 0
    s_cmp_ge_u32 s32, 1
    s_cbranch_scc1 Lmd_131
    s_sub_u32 s33, s33, 1
    s_cbranch_scc1 Lmd_131
    s_sleep 2
    s_branch Lms_130
Lmd_131:
    ds_read_b64_tr_b16 v[128:129], v18 offset:0
    ds_read_b64_tr_b16 v[130:131], v18 offset:512
    ds_read_b64_tr_b16 v[132:133], v18 offset:4096
    ds_read_b64_tr_b16 v[134:135], v18 offset:4608
    ds_read_b64_tr_b16 v[136:137], v18 offset:8192
    ds_read_b64_tr_b16 v[138:139], v18 offset:8704
    ds_read_b64_tr_b16 v[140:141], v18 offset:12288
    ds_read_b64_tr_b16 v[142:143], v18 offset:12800
    s_waitcnt lgkmcnt(6)
    v_mfma_f32_16x16x32_bf16 v[100:103], v[128:131], v[40:43], 0
    ds_read_b64_tr_b16 v[144:145], v18 offset:16384
    ds_read_b64_tr_b16 v[146:147], v18 offset:16896
    s_waitcnt lgkmcnt(6)
    v_mfma_f32_16x16x32_bf16 v[104:107], v[132:135], v[44:47], 0
    ds_read_b64_tr_b16 v[148:149], v18 offset:20480
    ds_read_b64_tr_b16 v[150:151], v18 offset:20992
    s_waitcnt lgkmcnt(6)
    v_mfma_f32_16x16x32_bf16 v[100:103], v[136:139], v[48:51], v[100:103]
    ds_read_b64_tr_b16 v[152:153], v18 offset:24576
    ds_read_b64_tr_b16 v[154:155], v18 offset:25088
    s_waitcnt lgkmcnt(6)
    v_mfma_f32_16x16x32_bf16 v[104:107], v[140:143], v[52:55], v[104:107]
    ds_read_b64_tr_b16 v[156:157], v18 offset:28672
    ds_read_b64_tr_b16 v[158:159], v18 offset:29184
    s_waitcnt lgkmcnt(6)
    v_mfma_f32_16x16x32_bf16 v[100:103], v[144:147], v[56:59], v[100:103]
    s_waitcnt lgkmcnt(4)
    v_mfma_f32_16x16x32_bf16 v[104:107], v[148:151], v[60:63], v[104:107]
    s_waitcnt lgkmcnt(2)
    v_mfma_f32_16x16x32_bf16 v[100:103], v[152:155], v[64:67], v[100:103]
    s_waitcnt lgkmcnt(0)
    v_mfma_f32_16x16x32_bf16 v[104:107], v[156:159], v[68:71], v[104:107]
    ds_read_b128 v[40:43], v20 offset:512
    ds_read_b128 v[44:47], v20 offset:576
    ds_read_b128 v[48:51], v20 offset:640
    ds_read_b128 v[52:55], v20 offset:704
    ds_read_b128 v[56:59], v20 offset:768
    ds_read_b128 v[60:63], v20 offset:832
    ds_read_b128 v[64:67], v20 offset:896
    ds_read_b128 v[68:71], v20 offset:960
    v_mov_b32 v39, 142992
    s_mov_b32 s33, 2000000
Lms_132:
    ds_read_b128 v[124:127], v39
    s_waitcnt lgkmcnt(0)
    v_min3_u32 v124, v124, v125, v126
    v_min_u32 v124, v124, v127
    s_nop 0
    v_readfirstlane_b32 s32, v124
    s_nop 0
    s_cmp_ge_u32 s32, 2
    s_cbranch_scc1 Lmd_133
    s_sub_u32 s33, s33, 1
    s_cbranch_scc1 Lmd_133
    s_sleep 2
    s_branch Lms_132
Lmd_133:
    ds_read_b64_tr_b16 v[160:161], v18 offset:32768
    ds_read_b64_tr_b16 v[162:163], v18 offset:33280
    ds_read_b64_tr_b16 v[164:165], v18 offset:36864
    ds_read_b64_tr_b16 v[166:167], v18 offset:37376
    ds_read_b64_tr_b16 v[168:169], v18 offset:40960
    ds_read_b64_tr_b16 v[170:171], v18 offset:41472
    ds_read_b64_tr_b16 v[172:173], v18 offset:45056
    ds_read_b64_tr_b16 v[174:175], v18 offset:45568
    s_waitcnt lgkmcnt(6)
    v_mfma_f32_16x16x32_bf16 v[100:103], v[160:163], v[40:43], v[100:103]
    ds_read_b64_tr_b16 v[176:177], v18 offset:49152
    ds_read_b64_tr_b16 v[178:179], v18 offset:49664
    s_waitcnt lgkmcnt(6)
    v_mfma_f32_16x16x32_bf16 v[104:107], v[164:167], v[44:47], v[104:107]
    ds_read_b64_tr_b16 v[180:181], v18 offset:53248
    ds_read_b64_tr_b16 v[182:183], v18 offset:53760
    s_waitcnt lgkmcnt(6)
    v_mfma_f32_16x16x32_bf16 v[100:103], v[168:171], v[48:51], v[100:103]
    ds_read_b64_tr_b16 v[184:185], v18 offset:57344
    ds_read_b64_tr_b16 v[186:187], v18 offset:57856
    s_waitcnt lgkmcnt(6)
    v_mfma_f32_16x16x32_bf16 v[104:107], v[172:175], v[52:55], v[104:107]
    ds_read_b64_tr_b16 v[188:189], v18 offset:61440
    ds_read_b64_tr_b16 v[190:191], v18 offset:61952
    s_waitcnt lgkmcnt(6)
    v_mfma_f32_16x16x32_bf16 v[100:103], v[176:179], v[56:59], v[100:103]
    s_waitcnt lgkmcnt(4)
    v_mfma_f32_16x16x32_bf16 v[104:107], v[180:183], v[60:63], v[104:107]
    s_waitcnt lgkmcnt(2)
    v_mfma_f32_16x16x32_bf16 v[100:103], v[184:187], v[64:67], v[100:103]
    s_waitcnt lgkmcnt(0)
    v_mfma_f32_16x16x32_bf16 v[104:107], v[188:191], v[68:71], v[104:107]
    ds_read_b128 v[40:43], v20 offset:1024
    ds_read_b128 v[44:47], v20 offset:1088
    ds_read_b128 v[48:51], v20 offset:1152
    ds_read_b128 v[52:55], v20 offset:1216
    ds_read_b128 v[56:59], v20 offset:1280
    ds_read_b128 v[60:63], v20 offset:1344
    ds_read_b128 v[64:67], v20 offset:1408
    ds_read_b128 v[68:71], v20 offset:1472
    v_mov_b32 v39, 142992
    s_mov_b32 s33, 2000000
Lms_134:
    ds_read_b128 v[124:127], v39
    s_waitcnt lgkmcnt(0)
    v_min3_u32 v124, v124, v125, v126
    v_min_u32 v124, v124, v127
    s_nop 0
    v_readfirstlane_b32 s32, v124
    s_nop 0
    s_cmp_ge_u32 s32, 3
    s_cbranch_scc1 Lmd_135
    s_sub_u32 s33, s33, 1
    s_cbranch_scc1 Lmd_135
    s_sleep 2
    s_branch Lms_134
Lmd_135:
    ds_read_b64_tr_b16 v[192:193], v19 offset:0
    ds_read_b64_tr_b16 v[194:195], v19 offset:512
    ds_read_b64_tr_b16 v[196:197], v19 offset:4096
    ds_read_b64_tr_b16 v[198:199], v19 offset:4608
    ds_read_b64_tr_b16 v[200:201], v19 offset:8192
    ds_read_b64_tr_b16 v[202:203], v19 offset:8704
    ds_read_b64_tr_b16 v[204:205], v19 offset:12288
    ds_read_b64_tr_b16 v[206:207], v19 offset:12800
    s_waitcnt lgkmcnt(6)
    v_mfma_f32_16x16x32_bf16 v[100:103], v[192:195], v[40:43], v[100:103]
    ds_read_b64_tr_b16 v[208:209], v19 offset:16384
    ds_read_b64_tr_b16 v[210:211], v19 offset:16896
    s_waitcnt lgkmcnt(6)
    v_mfma_f32_16x16x32_bf16 v[104:107], v[196:199], v[44:47], v[104:107]
    ds_read_b64_tr_b16 v[212:213], v19 offset:20480
    ds_read_b64_tr_b16 v[214:215], v19 offset:20992
    s_waitcnt lgkmcnt(6)
    v_mfma_f32_16x16x32_bf16 v[100:103], v[200:203], v[48:51], v[100:103]
    ds_read_b64_tr_b16 v[216:217], v19 offset:24576
    ds_read_b64_tr_b16 v[218:219], v19 offset:25088
    s_waitcnt lgkmcnt(6)
    v_mfma_f32_16x16x32_bf16 v[104:107], v[204:207], v[52:55], v[104:107]
    ds_read_b64_tr_b16 v[220:221], v19 offset:28672
    ds_read_b64_tr_b16 v[222:223], v19 offset:29184
    s_waitcnt lgkmcnt(6)
    v_mfma_f32_16x16x32_bf16 v[100:103], v[208:211], v[56:59], v[100:103]
    s_waitcnt lgkmcnt(4)
    v_mfma_f32_16x16x32_bf16 v[104:107], v[212:215], v[60:63], v[104:107]
    s_waitcnt lgkmcnt(2)
    v_mfma_f32_16x16x32_bf16 v[100:103], v[216:219], v[64:67], v[100:103]
    s_waitcnt lgkmcnt(0)
    v_mfma_f32_16x16x32_bf16 v[104:107], v[220:223], v[68:71], v[104:107]
    s_mov_b32 s8, s60
    s_mov_b32 s9, s61
    s_mov_b32 s10, 256
    s_mov_b32 s11, 0x20000
    v_and_b32 v11, 7, v0
    v_mul_u32_u24 v11, 32, v11
    buffer_load_dwordx2 v[6:7], v11, s[8:11], 0 offen sc1
    ds_read_b128 v[40:43], v20 offset:1536
    ds_read_b128 v[44:47], v20 offset:1600
    ds_read_b128 v[48:51], v20 offset:1664
    ds_read_b128 v[52:55], v20 offset:1728
    ds_read_b128 v[56:59], v20 offset:1792
    ds_read_b128 v[60:63], v20 offset:1856
    ds_read_b128 v[64:67], v20 offset:1920
    ds_read_b128 v[68:71], v20 offset:1984
    v_mov_b32 v39, 142992
    s_mov_b32 s33, 2000000
Lms_138:
    ds_read_b128 v[124:127], v39
    s_waitcnt lgkmcnt(0)
    v_min3_u32 v124, v124, v125, v126
    v_min_u32 v124, v124, v127
    s_nop 0
    v_readfirstlane_b32 s32, v124
    s_nop 0
    s_cmp_ge_u32 s32, 4
    s_cbranch_scc1 Lmd_139
    s_sub_u32 s33, s33, 1
    s_cbranch_scc1 Lmd_139
    s_sleep 2
    s_branch Lms_138
Lmd_139:
    ds_read_b64_tr_b16 v[224:225], v19 offset:32768
    ds_read_b64_tr_b16 v[226:227], v19 offset:33280
    ds_read_b64_tr_b16 v[228:229], v19 offset:36864
    ds_read_b64_tr_b16 v[230:231], v19 offset:37376
    ds_read_b64_tr_b16 v[232:233], v19 offset:40960
    ds_read_b64_tr_b16 v[234:235], v19 offset:41472
    ds_read_b64_tr_b16 v[236:237], v19 offset:45056
    ds_read_b64_tr_b16 v[238:239], v19 offset:45568
    s_waitcnt lgkmcnt(6)
    v_mfma_f32_16x16x32_bf16 v[100:103], v[224:227], v[40:43], v[100:103]
    ds_read_b64_tr_b16 v[240:241], v19 offset:49152
    ds_read_b64_tr_b16 v[242:243], v19 offset:49664
    s_waitcnt lgkmcnt(6)
    v_mfma_f32_16x16x32_bf16 v[104:107], v[228:231], v[44:47], v[104:107]
    ds_read_b64_tr_b16 v[244:245], v19 offset:53248
    ds_read_b64_tr_b16 v[246:247], v19 offset:53760
    s_waitcnt lgkmcnt(6)
    v_mfma_f32_16x16x32_bf16 v[100:103], v[232:235], v[48:51], v[100:103]
    ds_read_b64_tr_b16 v[248:249], v19 offset:57344
    ds_read_b64_tr_b16 v[250:251], v19 offset:57856
    s_waitcnt lgkmcnt(6)
    v_mfma_f32_16x16x32_bf16 v[104:107], v[236:239], v[52:55], v[104:107]
    ds_read_b64_tr_b16 v[252:253], v19 offset:61440
    ds_read_b64_tr_b16 v[254:255], v19 offset:61952
    s_waitcnt lgkmcnt(6)
    v_mfma_f32_16x16x32_bf16 v[100:103], v[240:243], v[56:59], v[100:103]
    s_waitcnt lgkmcnt(4)
    v_mfma_f32_16x16x32_bf16 v[104:107], v[244:247], v[60:63], v[104:107]
    s_waitcnt lgkmcnt(2)
    v_mfma_f32_16x16x32_bf16 v[100:103], v[248:251], v[64:67], v[100:103]
    s_waitcnt lgkmcnt(0)
    v_mfma_f32_16x16x32_bf16 v[104:107], v[252:255], v[68:71], v[104:107]
    s_mov_b32 s33, 150000
    s_branch Lpl_136_w
Lpl_136:
    buffer_load_dwordx2 v[6:7], v11, s[8:11], 0 offen sc1
Lpl_136_w:
    s_waitcnt vmcnt(0)
    v_sad_u8 v8, v6, 0, 0
    v_sad_u8 v8, v7, 0, v8
    v_max_u32 v8, 1, v8
    v_and_b32 v8, 31, v8
    v_cmp_ne_u32 vcc, 0, v8
    s_cbranch_vccz Lpd_137
    s_sub_u32 s33, s33, 1
    s_cbranch_scc1 Lpd_137
    s_sleep 16
    s_branch Lpl_136
Lpd_137:
    v_or_b32 v6, v6, v7
    v_and_b32 v6, 0x1f1f1f1f, v6
    v_cmp_ne_u32 vcc, 0, v6
    s_nop 0
    s_cmp_eq_u64 vcc, 0
    s_cselect_b32 s99, 1, 0
    s_cmp_lt_u32 s2, 96
    s_cbranch_scc1 L_mpub
    s_waitcnt lgkmcnt(0)
    v_mov_b32 v39, 143028
    v_mov_b32 v4, 1
    s_mov_b64 exec, 1
    ds_add_u32 v39, v4
    s_mov_b64 exec, -1
    s_mul_i32 s16, s30, 12288
    s_add_u32 s16, s16, 311296
    s_cmp_lg_u32 s30, 3
    s_cbranch_scc1 Lct_140
    s_lshr_b32 s78, s2, 6
    s_and_b32 s79, s2, 63
    s_mul_i32 s79, s79, 0
    s_add_u32 s78, s78, s79
    s_and_b32 s78, s78, 3
    s_mul_i32 s78, s78, 1024
    s_add_u32 s78, s78, 229376
    s_add_u32 s76, s62, s78
    s_addc_u32 s77, s63, 0
    v_mov_b32 v39, 142992
    s_mov_b32 s33, 2000000
Lms_141:
    ds_read_b128 v[124:127], v39
    s_waitcnt lgkmcnt(0)
    v_min3_u32 v124, v124, v125, v126
    v_min_u32 v124, v124, v127
    s_nop 0
    v_readfirstlane_b32 s32, v124
    s_nop 0
    s_cmp_ge_u32 s32, 5
    s_cbranch_scc1 Lmd_142
    s_sub_u32 s33, s33, 1
    s_cbranch_scc1 Lmd_142
    s_sleep 2
    s_branch Lms_141
Lmd_142:
    s_mov_b32 s80, 1
    s_atomic_add s80, s[76:77], 0 glc
    s_waitcnt lgkmcnt(0)
    s_add_u32 s79, s80, 1
    s_cmp_ge_u32 s79, 999
    s_cselect_b32 s80, 2, 0
    s_cmp_ge_u32 s79, 43
    s_cselect_b32 s79, 1, s80
    v_mov_b32 v4, s79
    v_mov_b32 v39, 143024
    ds_write_b32 v39, v4
    s_lshr_b32 s78, s2, 6
    s_and_b32 s79, s2, 63
    s_mul_i32 s79, s79, 5
    s_add_u32 s78, s78, s79
    s_and_b32 s78, s78, 3
    s_mul_i32 s78, s78, 1024
    s_add_u32 s78, s78, 233472
    s_add_u32 s76, s62, s78
    s_addc_u32 s77, s63, 0
    v_mov_b32 v39, 142992
    s_mov_b32 s33, 2000000
Lms_143:
    ds_read_b128 v[124:127], v39
    s_waitcnt lgkmcnt(0)
    v_min3_u32 v124, v124, v125, v126
    v_min_u32 v124, v124, v127
    s_nop 0
    v_readfirstlane_b32 s32, v124
    s_nop 0
    s_cmp_ge_u32 s32, 6
    s_cbranch_scc1 Lmd_144
    s_sub_u32 s33, s33, 1
    s_cbranch_scc1 Lmd_144
    s_sleep 2
    s_branch Lms_143
Lmd_144:
    s_mov_b32 s80, 1
    s_atomic_add s80, s[76:77], 0 glc
    s_waitcnt lgkmcnt(0)
    s_add_u32 s79, s80, 1
    s_cmp_ge_u32 s79, 999
    s_cselect_b32 s80, 2, 0
    s_cmp_ge_u32 s79, 43
    s_cselect_b32 s79, 1, s80
    v_mov_b32 v4, s79
    v_mov_b32 v39, 143024
    ds_write_b32 v39, v4
Lct_140:
    v_mov_b32 v39, 142992
    s_mov_b32 s33, 2000000
Lms_145:
    ds_read_b128 v[124:127], v39
    s_waitcnt lgkmcnt(0)
    v_min3_u32 v124, v124, v125, v126
    v_min_u32 v124, v124, v127
    s_nop 0
    v_readfirstlane_b32 s32, v124
    s_nop 0
    s_cmp_ge_u32 s32, 7
    s_cbranch_scc1 Lmd_146
    s_sub_u32 s33, s33, 1
    s_cbranch_scc1 Lmd_146
    s_sleep 2
    s_branch Lms_145
Lmd_146:
    buffer_load_dwordx2 v[88:89], v16, s[12:15], s16 offen offset:0 sc1
    buffer_load_dwordx2 v[90:91], v16, s[12:15], s16 offen offset:512 sc1
    buffer_load_dwordx2 v[92:93], v16, s[12:15], s16 offen offset:1024 sc1
    buffer_load_dwordx2 v[94:95], v16, s[12:15], s16 offen offset:1536 sc1
    buffer_load_dwordx2 v[96:97], v16, s[12:15], s16 offen offset:2048 sc1
    buffer_load_dwordx2 v[98:99], v16, s[12:15], s16 offen offset:2560 sc1
    buffer_load_dwordx2 v[100:101], v16, s[12:15], s16 offen offset:3072 sc1
    buffer_load_dwordx2 v[102:103], v16, s[12:15], s16 offen offset:3584 sc1
    s_mov_b32 s33, 150000
Lpl_147:
    s_waitcnt vmcnt(0)
    v_max3_u32 v4, v88, v90, v92
    v_max3_u32 v4, v4, v94, v96
    v_max3_u32 v4, v4, v98, v100
    v_max_u32 v4, v4, v102
    v_cmp_eq_u32 vcc, -1, v4
    s_cbranch_vccnz Lpl_147_r
Lpd_148:
    v_lshlrev_b32 v40, 16, v88
    v_and_b32 v41, 0xffff0000, v88
    v_lshlrev_b32 v42, 16, v89
    v_and_b32 v43, 0xffff0000, v89
    v_lshlrev_b32 v44, 16, v90
    v_and_b32 v45, 0xffff0000, v90
    v_lshlrev_b32 v46, 16, v91
    v_and_b32 v47, 0xffff0000, v91
    v_lshlrev_b32 v48, 16, v92
    v_and_b32 v49, 0xffff0000, v92
    v_lshlrev_b32 v50, 16, v93
    v_and_b32 v51, 0xffff0000, v93
    v_lshlrev_b32 v52, 16, v94
    v_and_b32 v53, 0xffff0000, v94
    v_lshlrev_b32 v54, 16, v95
    v_and_b32 v55, 0xffff0000, v95
    v_lshlrev_b32 v56, 16, v96
    v_and_b32 v57, 0xffff0000, v96
    v_lshlrev_b32 v58, 16, v97
    v_and_b32 v59, 0xffff0000, v97
    v_lshlrev_b32 v60, 16, v98
    v_and_b32 v61, 0xffff0000, v98
    v_lshlrev_b32 v62, 16, v99
    v_and_b32 v63, 0xffff0000, v99
    v_lshlrev_b32 v64, 16, v100
    v_and_b32 v65, 0xffff0000, v100
    v_lshlrev_b32 v66, 16, v101
    v_and_b32 v67, 0xffff0000, v101
    v_lshlrev_b32 v68, 16, v102
    v_and_b32 v69, 0xffff0000, v102
    v_lshlrev_b32 v70, 16, v103
    v_and_b32 v71, 0xffff0000, v103
    v_add_f32 v56, 1.0, v56
    v_add_f32 v57, 1.0, v57
    v_add_f32 v58, 1.0, v58
    v_add_f32 v59, 1.0, v59
    v_add_f32 v60, 1.0, v60
    v_add_f32 v61, 1.0, v61
    v_add_f32 v62, 1.0, v62
    v_add_f32 v63, 1.0, v63
    v_add_f32 v64, 1.0, v64
    v_add_f32 v65, 1.0, v65
    v_add_f32 v66, 1.0, v66
    v_add_f32 v67, 1.0, v67
    v_add_f32 v68, 1.0, v68
    v_add_f32 v69, 1.0, v69
    v_add_f32 v70, 1.0, v70
    v_add_f32 v71, 1.0, v71
    v_cvt_pk_bf16_f32 v56, 0, v56
    v_cvt_pk_bf16_f32 v57, 0, v57
    v_cvt_pk_bf16_f32 v58, 0, v58
    v_cvt_pk_bf16_f32 v59, 0, v59
    v_cvt_pk_bf16_f32 v60, 0, v60
    v_cvt_pk_bf16_f32 v61, 0, v61
    v_cvt_pk_bf16_f32 v62, 0, v62
    v_cvt_pk_bf16_f32 v63, 0, v63
    v_cvt_pk_bf16_f32 v64, 0, v64
    v_cvt_pk_bf16_f32 v65, 0, v65
    v_cvt_pk_bf16_f32 v66, 0, v66
    v_cvt_pk_bf16_f32 v67, 0, v67
    v_cvt_pk_bf16_f32 v68, 0, v68
    v_cvt_pk_bf16_f32 v69, 0, v69
    v_cvt_pk_bf16_f32 v70, 0, v70
    v_cvt_pk_bf16_f32 v71, 0, v71
    v_pk_mul_f32 v[72:73], v[72:73], v[56:57]
    v_pk_mul_f32 v[74:75], v[74:75], v[58:59]
    v_pk_mul_f32 v[76:77], v[76:77], v[60:61]
    v_pk_mul_f32 v[78:79], v[78:79], v[62:63]
    v_pk_mul_f32 v[80:81], v[80:81], v[64:65]
    v_pk_mul_f32 v[82:83], v[82:83], v[66:67]
    v_pk_mul_f32 v[84:85], v[84:85], v[68:69]
    v_pk_mul_f32 v[86:87], v[86:87], v[70:71]
    v_cvt_pk_bf16_f32 v72, 0, v72
    v_cvt_pk_bf16_f32 v73, 0, v73
    v_cvt_pk_bf16_f32 v74, 0, v74
    v_cvt_pk_bf16_f32 v75, 0, v75
    v_cvt_pk_bf16_f32 v76, 0, v76
    v_cvt_pk_bf16_f32 v77, 0, v77
    v_cvt_pk_bf16_f32 v78, 0, v78
    v_cvt_pk_bf16_f32 v79, 0, v79
    v_cvt_pk_bf16_f32 v80, 0, v80
    v_cvt_pk_bf16_f32 v81, 0, v81
    v_cvt_pk_bf16_f32 v82, 0, v82
    v_cvt_pk_bf16_f32 v83, 0, v83
    v_cvt_pk_bf16_f32 v84, 0, v84
    v_cvt_pk_bf16_f32 v85, 0, v85
    v_cvt_pk_bf16_f32 v86, 0, v86
    v_cvt_pk_bf16_f32 v87, 0, v87
    v_pk_add_f32 v[72:73], v[72:73], v[40:41]
    v_pk_add_f32 v[74:75], v[74:75], v[42:43]
    v_pk_add_f32 v[76:77], v[76:77], v[44:45]
    v_pk_add_f32 v[78:79], v[78:79], v[46:47]
    v_pk_add_f32 v[80:81], v[80:81], v[48:49]
    v_pk_add_f32 v[82:83], v[82:83], v[50:51]
    v_pk_add_f32 v[84:85], v[84:85], v[52:53]
    v_pk_add_f32 v[86:87], v[86:87], v[54:55]
    v_cvt_pk_bf16_f32 v40, v72, v73
    v_cvt_pk_bf16_f32 v41, v74, v75
    v_cvt_pk_bf16_f32 v42, v76, v77
    v_cvt_pk_bf16_f32 v43, v78, v79
    v_cvt_pk_bf16_f32 v44, v80, v81
    v_cvt_pk_bf16_f32 v45, v82, v83
    v_cvt_pk_bf16_f32 v46, v84, v85
    v_cvt_pk_bf16_f32 v47, v86, v87
    ds_write_b64 v15, v[40:41] offset:0
    ds_write_b64 v15, v[42:43] offset:32
    ds_write_b64 v15, v[44:45] offset:8
    ds_write_b64 v15, v[46:47] offset:40
    s_add_u32 s31, s31, 4
    s_waitcnt lgkmcnt(0)
    v_mov_b32 v39, 142976
    v_mov_b32 v4, 1
    s_mov_b64 exec, 1
    ds_add_u32 v39, v4
    s_mov_b64 exec, -1
    v_mov_b32 v39, 142976
    s_mov_b32 s33, 2000000
Lsp_157:
    ds_read_b32 v4, v39
    s_waitcnt lgkmcnt(0)
    v_readfirstlane_b32 s32, v4
    s_nop 0
    s_cmp_ge_u32 s32, s31
    s_cbranch_scc1 Lsd_158
    s_sub_u32 s33, s33, 1
    s_cbranch_scc1 Lsd_158
    s_sleep 1
    s_branch Lsp_157
Lsd_158:
    ds_read_b128 v[40:43], v20 offset:0
    ds_read_b128 v[44:47], v20 offset:64
    ds_read_b128 v[48:51], v20 offset:128
    ds_read_b128 v[52:55], v20 offset:192
    ds_read_b128 v[56:59], v20 offset:256
    ds_read_b128 v[60:63], v20 offset:320
    ds_read_b128 v[64:67], v20 offset:384
    ds_read_b128 v[68:71], v20 offset:448
    s_waitcnt lgkmcnt(7)
    v_mfma_f32_16x16x32_bf16 v[100:103], v[128:131], v[40:43], 0
    ds_read_b128 v[40:43], v20 offset:512
    s_waitcnt lgkmcnt(7)
    v_mfma_f32_16x16x32_bf16 v[104:107], v[132:135], v[44:47], 0
    ds_read_b128 v[44:47], v20 offset:576
    s_waitcnt lgkmcnt(7)
    v_mfma_f32_16x16x32_bf16 v[100:103], v[136:139], v[48:51], v[100:103]
    ds_read_b128 v[48:51], v20 offset:640
    s_waitcnt lgkmcnt(7)
    v_mfma_f32_16x16x32_bf16 v[104:107], v[140:143], v[52:55], v[104:107]
    ds_read_b128 v[52:55], v20 offset:704
    s_waitcnt lgkmcnt(7)
    v_mfma_f32_16x16x32_bf16 v[100:103], v[144:147], v[56:59], v[100:103]
    ds_read_b128 v[56:59], v20 offset:768
    s_waitcnt lgkmcnt(7)
    v_mfma_f32_16x16x32_bf16 v[104:107], v[148:151], v[60:63], v[104:107]
    ds_read_b128 v[60:63], v20 offset:832
    s_waitcnt lgkmcnt(7)
    v_mfma_f32_16x16x32_bf16 v[100:103], v[152:155], v[64:67], v[100:103]
    ds_read_b128 v[64:67], v20 offset:896
    s_waitcnt lgkmcnt(7)
    v_mfma_f32_16x16x32_bf16 v[104:107], v[156:159], v[68:71], v[104:107]
    ds_read_b128 v[68:71], v20 offset:960
    s_waitcnt lgkmcnt(7)
    v_mfma_f32_16x16x32_bf16 v[100:103], v[160:163], v[40:43], v[100:103]
    ds_read_b128 v[40:43], v20 offset:1024
    s_waitcnt lgkmcnt(7)
    v_mfma_f32_16x16x32_bf16 v[104:107], v[164:167], v[44:47], v[104:107]
    ds_read_b128 v[44:47], v20 offset:1088
    s_waitcnt lgkmcnt(7)
    v_mfma_f32_16x16x32_bf16 v[100:103], v[168:171], v[48:51], v[100:103]
    ds_read_b128 v[48:51], v20 offset:1152
    s_waitcnt lgkmcnt(7)
    v_mfma_f32_16x16x32_bf16 v[104:107], v[172:175], v[52:55], v[104:107]
    ds_read_b128 v[52:55], v20 offset:1216
    s_waitcnt lgkmcnt(7)
    v_mfma_f32_16x16x32_bf16 v[100:103], v[176:179], v[56:59], v[100:103]
    ds_read_b128 v[56:59], v20 offset:1280
    s_waitcnt lgkmcnt(7)
    v_mfma_f32_16x16x32_bf16 v[104:107], v[180:183], v[60:63], v[104:107]
    ds_read_b128 v[60:63], v20 offset:1344
    s_waitcnt lgkmcnt(7)
    v_mfma_f32_16x16x32_bf16 v[100:103], v[184:187], v[64:67], v[100:103]
    ds_read_b128 v[64:67], v20 offset:1408
    s_waitcnt lgkmcnt(7)
    v_mfma_f32_16x16x32_bf16 v[104:107], v[188:191], v[68:71], v[104:107]
    ds_read_b128 v[68:71], v20 offset:1472
    s_waitcnt lgkmcnt(7)
    v_mfma_f32_16x16x32_bf16 v[100:103], v[192:195], v[40:43], v[100:103]
    ds_read_b128 v[40:43], v20 offset:1536
    s_waitcnt lgkmcnt(7)
    v_mfma_f32_16x16x32_bf16 v[104:107], v[196:199], v[44:47], v[104:107]
    ds_read_b128 v[44:47], v20 offset:1600
    s_waitcnt lgkmcnt(7)
    v_mfma_f32_16x16x32_bf16 v[100:103], v[200:203], v[48:51], v[100:103]
    ds_read_b128 v[48:51], v20 offset:1664
    s_waitcnt lgkmcnt(7)
    v_mfma_f32_16x16x32_bf16 v[104:107], v[204:207], v[52:55], v[104:107]
    ds_read_b128 v[52:55], v20 offset:1728
    s_waitcnt lgkmcnt(7)
    v_mfma_f32_16x16x32_bf16 v[100:103], v[208:211], v[56:59], v[100:103]
    ds_read_b128 v[56:59], v20 offset:1792
    s_waitcnt lgkmcnt(7)
    v_mfma_f32_16x16x32_bf16 v[104:107], v[212:215], v[60:63], v[104:107]
    ds_read_b128 v[60:63], v20 offset:1856
    s_waitcnt lgkmcnt(7)
    v_mfma_f32_16x16x32_bf16 v[100:103], v[216:219], v[64:67], v[100:103]
    ds_read_b128 v[64:67], v20 offset:1920
    s_waitcnt lgkmcnt(7)
    v_mfma_f32_16x16x32_bf16 v[104:107], v[220:223], v[68:71], v[104:107]
    ds_read_b128 v[68:71], v20 offset:1984
    s_waitcnt lgkmcnt(7)
    v_mfma_f32_16x16x32_bf16 v[100:103], v[224:227], v[40:43], v[100:103]
    s_waitcnt lgkmcnt(6)
    v_mfma_f32_16x16x32_bf16 v[104:107], v[228:231], v[44:47], v[104:107]
    s_waitcnt lgkmcnt(5)
    v_mfma_f32_16x16x32_bf16 v[100:103], v[232:235], v[48:51], v[100:103]
    s_waitcnt lgkmcnt(4)
    v_mfma_f32_16x16x32_bf16 v[104:107], v[236:239], v[52:55], v[104:107]
    s_waitcnt lgkmcnt(3)
    v_mfma_f32_16x16x32_bf16 v[100:103], v[240:243], v[56:59], v[100:103]
    s_waitcnt lgkmcnt(2)
    v_mfma_f32_16x16x32_bf16 v[104:107], v[244:247], v[60:63], v[104:107]
    s_waitcnt lgkmcnt(1)
    v_mfma_f32_16x16x32_bf16 v[100:103], v[248:251], v[64:67], v[100:103]
    s_waitcnt lgkmcnt(0)
    v_mfma_f32_16x16x32_bf16 v[104:107], v[252:255], v[68:71], v[104:107]
L_mpub:
    v_mul_lo_u32 v14, v1, s22
    v_lshl_add_u32 v14, v2, 3, v14
    s_cmp_lt_u32 s2, 96
    s_cselect_b32 s24, 0, 49152
    s_add_u32 s24, s24, 311296
    s_lshl_b32 s25, s30, 5
    s_add_u32 s25, s25, s23
    s_add_u32 s24, s24, s25
    v_pk_add_f32 v[100:101], v[100:101], v[104:105]
    v_pk_add_f32 v[102:103], v[102:103], v[106:107]
    v_cvt_pk_bf16_f32 v6, v100, v101
    v_cvt_pk_bf16_f32 v7, v102, v103
    v_min_u32 v6, -2, v6
    s_mov_b32 exec_lo, 0x000f000f
    s_mov_b32 exec_hi, 0x000f000f
    buffer_store_dwordx2 v[6:7], v14, s[12:15], s24 offen sc1
    s_mov_b64 exec, -1
    s_cmp_lt_u32 s2, 96
    s_cbranch_scc1 L_mid
    s_branch L_mid2
Lpl_147_r:
    s_sub_u32 s33, s33, 1
    s_cbranch_scc1 Lpd_148
    s_sleep 16
    v_cmp_eq_u32 vcc, -1, v88
    s_cbranch_vccz Lsk_149
    s_mov_b64 exec, vcc
    buffer_load_dwordx2 v[88:89], v16, s[12:15], s16 offen offset:0 sc1
    s_mov_b64 exec, -1
Lsk_149:
    v_cmp_eq_u32 vcc, -1, v90
    s_cbranch_vccz Lsk_150
    s_mov_b64 exec, vcc
    buffer_load_dwordx2 v[90:91], v16, s[12:15], s16 offen offset:512 sc1
    s_mov_b64 exec, -1
Lsk_150:
    v_cmp_eq_u32 vcc, -1, v92
    s_cbranch_vccz Lsk_151
    s_mov_b64 exec, vcc
    buffer_load_dwordx2 v[92:93], v16, s[12:15], s16 offen offset:1024 sc1
    s_mov_b64 exec, -1
Lsk_151:
    v_cmp_eq_u32 vcc, -1, v94
    s_cbranch_vccz Lsk_152
    s_mov_b64 exec, vcc
    buffer_load_dwordx2 v[94:95], v16, s[12:15], s16 offen offset:1536 sc1
    s_mov_b64 exec, -1
Lsk_152:
    v_cmp_eq_u32 vcc, -1, v96
    s_cbranch_vccz Lsk_153
    s_mov_b64 exec, vcc
    buffer_load_dwordx2 v[96:97], v16, s[12:15], s16 offen offset:2048 sc1
    s_mov_b64 exec, -1
Lsk_153:
    v_cmp_eq_u32 vcc, -1, v98
    s_cbranch_vccz Lsk_154
    s_mov_b64 exec, vcc
    buffer_load_dwordx2 v[98:99], v16, s[12:15], s16 offen offset:2560 sc1
    s_mov_b64 exec, -1
Lsk_154:
    v_cmp_eq_u32 vcc, -1, v100
    s_cbranch_vccz Lsk_155
    s_mov_b64 exec, vcc
    buffer_load_dwordx2 v[100:101], v16, s[12:15], s16 offen offset:3072 sc1
    s_mov_b64 exec, -1
Lsk_155:
    v_cmp_eq_u32 vcc, -1, v102
    s_cbranch_vccz Lsk_156
    s_mov_b64 exec, vcc
    buffer_load_dwordx2 v[102:103], v16, s[12:15], s16 offen offset:3584 sc1
    s_mov_b64 exec, -1
Lsk_156:
    s_branch Lpl_147
L_rwo:
    v_lshrrev_b32 v14, 2, v1
    v_lshl_add_u32 v14, v2, 2, v14
    s_lshl_b32 s24, s30, 1
    v_and_b32 v6, 3, v1
    v_lshlrev_b32 v6, 3, v6
    v_lshl_add_u32 v6, v14, 8, v6
    s_mov_b32 s25, 7
    v_and_b32 v15, s25, v14
    v_xor_b32 v15, s24, v15
    v_lshl_add_u32 v18, v15, 5, v6
    v_xor_b32 v19, 32, v18
    s_mov_b32 s25, 7
    v_and_b32 v15, s25, v14
    v_xor_b32 v15, s24, v15
    v_lshl_add_u32 v20, v15, 5, v6
    v_add_u32 v20, 65536, v20
    v_xor_b32 v21, 32, v20
    v_mov_b32 v39, 142992
    s_mov_b32 s33, 2000000
Lms_159:
    ds_read_b128 v[124:127], v39
    s_waitcnt lgkmcnt(0)
    v_min3_u32 v124, v124, v125, v126
    v_min_u32 v124, v124, v127
    s_nop 0
    v_readfirstlane_b32 s32, v124
    s_nop 0
    s_cmp_ge_u32 s32, 4
    s_cbranch_scc1 Lmd_160
    s_sub_u32 s33, s33, 1
    s_cbranch_scc1 Lmd_160
    s_sleep 2
    s_branch Lms_159
Lmd_160:
    ds_read_b64_tr_b16 v[192:193], v20 offset:0
    ds_read_b64_tr_b16 v[196:197], v21 offset:0
    ds_read_b64_tr_b16 v[194:195], v20 offset:4096
    ds_read_b64_tr_b16 v[198:199], v21 offset:4096
    ds_read_b64_tr_b16 v[200:201], v20 offset:8192
    ds_read_b64_tr_b16 v[204:205], v21 offset:8192
    ds_read_b64_tr_b16 v[202:203], v20 offset:12288
    ds_read_b64_tr_b16 v[206:207], v21 offset:12288
    s_waitcnt lgkmcnt(4)
    ds_read_b64_tr_b16 v[208:209], v20 offset:16384
    ds_read_b64_tr_b16 v[212:213], v21 offset:16384
    ds_read_b64_tr_b16 v[210:211], v20 offset:20480
    ds_read_b64_tr_b16 v[214:215], v21 offset:20480
    ds_read_b64_tr_b16 v[216:217], v20 offset:24576
    ds_read_b64_tr_b16 v[220:221], v21 offset:24576
    ds_read_b64_tr_b16 v[218:219], v20 offset:28672
    ds_read_b64_tr_b16 v[222:223], v21 offset:28672
    s_waitcnt lgkmcnt(4)
    ds_read_b64_tr_b16 v[224:225], v20 offset:32768
    ds_read_b64_tr_b16 v[228:229], v21 offset:32768
    ds_read_b64_tr_b16 v[226:227], v20 offset:36864
    ds_read_b64_tr_b16 v[230:231], v21 offset:36864
    ds_read_b64_tr_b16 v[232:233], v20 offset:40960
    ds_read_b64_tr_b16 v[236:237], v21 offset:40960
    ds_read_b64_tr_b16 v[234:235], v20 offset:45056
    ds_read_b64_tr_b16 v[238:239], v21 offset:45056
    s_waitcnt lgkmcnt(4)
    ds_read_b64_tr_b16 v[240:241], v20 offset:49152
    ds_read_b64_tr_b16 v[244:245], v21 offset:49152
    ds_read_b64_tr_b16 v[242:243], v20 offset:53248
    ds_read_b64_tr_b16 v[246:247], v21 offset:53248
    ds_read_b64_tr_b16 v[248:249], v20 offset:57344
    ds_read_b64_tr_b16 v[252:253], v21 offset:57344
    ds_read_b64_tr_b16 v[250:251], v20 offset:61440
    ds_read_b64_tr_b16 v[254:255], v21 offset:61440
    s_waitcnt lgkmcnt(4)
    s_waitcnt lgkmcnt(0)
    s_cmp_lt_u32 s2, 224
    s_cbranch_scc1 L_mid0
    ds_read_b64_tr_b16 v[128:129], v18 offset:0
    ds_read_b64_tr_b16 v[132:133], v19 offset:0
    ds_read_b64_tr_b16 v[130:131], v18 offset:4096
    ds_read_b64_tr_b16 v[134:135], v19 offset:4096
    ds_read_b64_tr_b16 v[136:137], v18 offset:8192
    ds_read_b64_tr_b16 v[140:141], v19 offset:8192
    ds_read_b64_tr_b16 v[138:139], v18 offset:12288
    ds_read_b64_tr_b16 v[142:143], v19 offset:12288
    s_waitcnt lgkmcnt(4)
    ds_read_b64_tr_b16 v[144:145], v18 offset:16384
    ds_read_b64_tr_b16 v[148:149], v19 offset:16384
    ds_read_b64_tr_b16 v[146:147], v18 offset:20480
    ds_read_b64_tr_b16 v[150:151], v19 offset:20480
    ds_read_b64_tr_b16 v[152:153], v18 offset:24576
    ds_read_b64_tr_b16 v[156:157], v19 offset:24576
    ds_read_b64_tr_b16 v[154:155], v18 offset:28672
    ds_read_b64_tr_b16 v[158:159], v19 offset:28672
    s_waitcnt lgkmcnt(4)
    ds_read_b64_tr_b16 v[160:161], v18 offset:32768
    ds_read_b64_tr_b16 v[164:165], v19 offset:32768
    ds_read_b64_tr_b16 v[162:163], v18 offset:36864
    ds_read_b64_tr_b16 v[166:167], v19 offset:36864
    ds_read_b64_tr_b16 v[168:169], v18 offset:40960
    ds_read_b64_tr_b16 v[172:173], v19 offset:40960
    ds_read_b64_tr_b16 v[170:171], v18 offset:45056
    ds_read_b64_tr_b16 v[174:175], v19 offset:45056
    s_waitcnt lgkmcnt(4)
    ds_read_b64_tr_b16 v[176:177], v18 offset:49152
    ds_read_b64_tr_b16 v[180:181], v19 offset:49152
    ds_read_b64_tr_b16 v[178:179], v18 offset:53248
    ds_read_b64_tr_b16 v[182:183], v19 offset:53248
    ds_read_b64_tr_b16 v[184:185], v18 offset:57344
    ds_read_b64_tr_b16 v[188:189], v19 offset:57344
    ds_read_b64_tr_b16 v[186:187], v18 offset:61440
    ds_read_b64_tr_b16 v[190:191], v19 offset:61440
    s_waitcnt lgkmcnt(4)
L_mid0:
    s_mov_b32 s8, s60
    s_mov_b32 s9, s61
    s_mov_b32 s10, 256
    s_mov_b32 s11, 0x20000
    v_and_b32 v11, 7, v0
    v_mul_u32_u24 v11, 32, v11
    s_mov_b32 s33, 150000
Lpl_161:
    buffer_load_dwordx2 v[6:7], v11, s[8:11], 0 offen sc1
Lpl_161_w:
    s_waitcnt vmcnt(0)
    v_sad_u8 v8, v6, 0, 0
    v_sad_u8 v8, v7, 0, v8
    v_max_u32 v8, 1, v8
    v_and_b32 v8, 31, v8
    v_cmp_ne_u32 vcc, 0, v8
    s_cbranch_vccz Lpd_162
    s_sub_u32 s33, s33, 1
    s_cbranch_scc1 Lpd_162
    s_sleep 16
    s_branch Lpl_161
Lpd_162:
    v_or_b32 v6, v6, v7
    v_and_b32 v6, 0x1f1f1f1f, v6
    v_cmp_ne_u32 vcc, 0, v6
    s_nop 0
    s_cmp_eq_u64 vcc, 0
    s_cselect_b32 s99, 1, 0
L_mid:
    s_waitcnt lgkmcnt(0)
    v_mov_b32 v39, 143028
    v_mov_b32 v4, 1
    s_mov_b64 exec, 1
    ds_add_u32 v39, v4
    s_mov_b64 exec, -1
    s_cmp_lg_u32 s30, 3
    s_cbranch_scc1 Lct_163
    s_lshr_b32 s78, s2, 6
    s_and_b32 s79, s2, 63
    s_mul_i32 s79, s79, 0
    s_add_u32 s78, s78, s79
    s_and_b32 s78, s78, 3
    s_mul_i32 s78, s78, 1024
    s_add_u32 s78, s78, 229376
    s_add_u32 s76, s62, s78
    s_addc_u32 s77, s63, 0
    v_mov_b32 v39, 142992
    s_mov_b32 s33, 2000000
Lms_164:
    ds_read_b128 v[124:127], v39
    s_waitcnt lgkmcnt(0)
    v_min3_u32 v124, v124, v125, v126
    v_min_u32 v124, v124, v127
    s_nop 0
    v_readfirstlane_b32 s32, v124
    s_nop 0
    s_cmp_ge_u32 s32, 5
    s_cbranch_scc1 Lmd_165
    s_sub_u32 s33, s33, 1
    s_cbranch_scc1 Lmd_165
    s_sleep 2
    s_branch Lms_164
Lmd_165:
    s_mov_b32 s80, 1
    s_atomic_add s80, s[76:77], 0 glc
    s_waitcnt lgkmcnt(0)
    s_add_u32 s79, s80, 1
    s_cmp_ge_u32 s79, 999
    s_cselect_b32 s80, 2, 0
    s_cmp_ge_u32 s79, 43
    s_cselect_b32 s79, 1, s80
    v_mov_b32 v4, s79
    v_mov_b32 v39, 143024
    ds_write_b32 v39, v4
    s_lshr_b32 s78, s2, 6
    s_and_b32 s79, s2, 63
    s_mul_i32 s79, s79, 5
    s_add_u32 s78, s78, s79
    s_and_b32 s78, s78, 3
    s_mul_i32 s78, s78, 1024
    s_add_u32 s78, s78, 233472
    s_add_u32 s76, s62, s78
    s_addc_u32 s77, s63, 0
    v_mov_b32 v39, 142992
    s_mov_b32 s33, 2000000
Lms_166:
    ds_read_b128 v[124:127], v39
    s_waitcnt lgkmcnt(0)
    v_min3_u32 v124, v124, v125, v126
    v_min_u32 v124, v124, v127
    s_nop 0
    v_readfirstlane_b32 s32, v124
    s_nop 0
    s_cmp_ge_u32 s32, 6
    s_cbranch_scc1 Lmd_167
    s_sub_u32 s33, s33, 1
    s_cbranch_scc1 Lmd_167
    s_sleep 2
    s_branch Lms_166
Lmd_167:
    s_mov_b32 s80, 1
    s_atomic_add s80, s[76:77], 0 glc
    s_waitcnt lgkmcnt(0)
    s_add_u32 s79, s80, 1
    s_cmp_ge_u32 s79, 999
    s_cselect_b32 s80, 2, 0
    s_cmp_ge_u32 s79, 43
    s_cselect_b32 s79, 1, s80
    v_mov_b32 v4, s79
    v_mov_b32 v39, 143024
    ds_write_b32 v39, v4
Lct_163:
L_mid2:
    s_lshr_b32 s24, s69, 4
    s_lshl_b32 s24, s24, 11
    s_lshl_b32 s25, s30, 9
    s_add_u32 s24, s24, s25
    s_add_u32 s24, s24, 360448
    s_lshl_b32 s25, s30, 1
    v_lshrrev_b32 v14, 5, v0
    v_add_u32 v14, s25, v14
    v_mul_u32_u24 v14, 272, v14
    v_add_u32 v14, v17, v14
    v_add_u32 v14, 139520, v14
    s_cmp_lg_u32 s30, 3
    s_cbranch_scc1 Lct_168
    s_lshr_b32 s78, s2, 6
    s_and_b32 s79, s2, 63
    s_mul_i32 s79, s79, 10
    s_add_u32 s78, s78, s79
    s_and_b32 s78, s78, 3
    s_mul_i32 s78, s78, 1024
    s_add_u32 s78, s78, 237568
    s_add_u32 s76, s62, s78
    s_addc_u32 s77, s63, 0
    v_mov_b32 v39, 142992
    s_mov_b32 s33, 2000000
Lms_169:
    ds_read_b128 v[124:127], v39
    s_waitcnt lgkmcnt(0)
    v_min3_u32 v124, v124, v125, v126
    v_min_u32 v124, v124, v127
    s_nop 0
    v_readfirstlane_b32 s32, v124
    s_nop 0
    s_cmp_ge_u32 s32, 8
    s_cbranch_scc1 Lmd_170
    s_sub_u32 s33, s33, 1
    s_cbranch_scc1 Lmd_170
    s_sleep 2
    s_branch Lms_169
Lmd_170:
    s_mov_b32 s80, 1
    s_atomic_add s80, s[76:77], 0 glc
    s_waitcnt lgkmcnt(0)
    s_add_u32 s79, s80, 1
    s_cmp_ge_u32 s79, 999
    s_cselect_b32 s80, 2, 0
    s_cmp_ge_u32 s79, 43
    s_cselect_b32 s79, 1, s80
    v_mov_b32 v4, s79
    v_mov_b32 v39, 143024
    ds_write_b32 v39, v4
Lct_168:
    v_mov_b32 v39, 142992
    s_mov_b32 s33, 2000000
Lms_171:
    ds_read_b128 v[124:127], v39
    s_waitcnt lgkmcnt(0)
    v_min3_u32 v124, v124, v125, v126
    v_min_u32 v124, v124, v127
    s_nop 0
    v_readfirstlane_b32 s32, v124
    s_nop 0
    s_cmp_ge_u32 s32, 9
    s_cbranch_scc1 Lmd_172
    s_sub_u32 s33, s33, 1
    s_cbranch_scc1 Lmd_172
    s_sleep 2
    s_branch Lms_171
Lmd_172:
    s_bfe_u32 s26, s2, 131073
    s_lshl_b32 s26, s26, 9
    s_mul_i32 s25, s30, 12288
    s_add_u32 s26, s26, s25
    s_add_u32 s26, s26, 317440
    buffer_load_dwordx2 v[6:7], v16, s[12:15], s24 offen sc1
    buffer_load_dwordx2 v[80:81], v16, s[12:15], s26 offen offset:2048 sc1
    buffer_load_dwordx2 v[82:83], v16, s[12:15], s26 offen offset:0 sc1
    s_mov_b32 s33, 150000
Lpl_173:
    s_waitcnt vmcnt(0)
    v_max3_u32 v4, v6, v80, v82
    v_cmp_eq_u32 vcc, -1, v4
    s_cbranch_vccnz Lpl_173_r
Lpd_174:
    ds_write_b64 v14, v[6:7]
    v_mov_b32 v14, 142988
    v_mov_b32 v8, s99
    ds_write_b32 v14, v8
    s_waitcnt lgkmcnt(0)
    v_mov_b32 v39, 142980
    v_mov_b32 v4, 1
    s_mov_b64 exec, 1
    ds_add_u32 v39, v4
    s_mov_b64 exec, -1
    s_setprio 0
    s_and_b32 s24, s2, 7
    s_lshl_b32 s24, s24, 2
    s_bfe_u32 s25, s2, 0x20003
    s_add_u32 s24, s24, s25
    s_lshl_b32 s100, s24, 1
    s_and_b32 s25, s30, 1
    s_add_u32 s100, s100, s25
    v_and_b32 v14, 1, v2
    v_lshlrev_b32 v14, 5, v14
    v_and_b32 v15, 3, v1
    v_lshl_add_u32 v14, v15, 3, v14
    s_lshl_b32 s24, s24, 6
    v_add_u32 v14, s24, v14
    v_bfe_u32 v15, v1, 2, 1
    v_lshl_add_u32 v15, s25, 1, v15
    v_lshl_add_u32 v31, v15, 11, v14
    s_cmp_lt_u32 s2, 224
    s_cselect_b32 s35, 2, s30
    s_cmp_ge_u32 s35, 2
    s_cbranch_scc1 L_noown
    s_mov_b32 s8, s36
    s_mov_b32 s9, s37
    s_mov_b32 s10, 8192
    s_mov_b32 s11, 0x20000
    buffer_load_dwordx2 v[8:9], v31, s[8:11], 0 offen
    v_mul_u32_u24 v15, 12288, v15
    v_add_u32 v14, v14, v15
    s_mov_b32 s16, 315392
    s_mov_b32 s17, 319488
    s_mov_b32 s18, 321536
    buffer_load_dwordx2 v[72:73], v14, s[12:15], s16 offen sc1
    buffer_load_dwordx2 v[74:75], v14, s[12:15], s17 offen sc1
    buffer_load_dwordx2 v[76:77], v14, s[12:15], s18 offen sc1
    s_mov_b32 s33, 150000
Lpl_178:
    s_waitcnt vmcnt(0)
    v_max3_u32 v4, v72, v74, v76
    v_cmp_eq_u32 vcc, -1, v4
    s_cbranch_vccnz Lpl_178_r
Lpd_179:
    v_lshlrev_b32 v108, 16, v8
    v_and_b32 v109, 0xffff0000, v8
    v_lshlrev_b32 v110, 16, v9
    v_and_b32 v111, 0xffff0000, v9
    v_lshlrev_b32 v112, 16, v72
    v_and_b32 v113, 0xffff0000, v72
    v_lshlrev_b32 v114, 16, v73
    v_and_b32 v115, 0xffff0000, v73
    v_lshlrev_b32 v120, 16, v74
    v_and_b32 v121, 0xffff0000, v74
    v_lshlrev_b32 v122, 16, v75
    v_and_b32 v123, 0xffff0000, v75
    v_lshlrev_b32 v116, 16, v76
    v_and_b32 v117, 0xffff0000, v76
    v_lshlrev_b32 v118, 16, v77
    v_and_b32 v119, 0xffff0000, v77
    v_add_f32 v120, 1.0, v120
    v_add_f32 v121, 1.0, v121
    v_add_f32 v122, 1.0, v122
    v_add_f32 v123, 1.0, v123
    v_cvt_pk_bf16_f32 v120, 0, v120
    v_cvt_pk_bf16_f32 v121, 0, v121
    v_cvt_pk_bf16_f32 v122, 0, v122
    v_cvt_pk_bf16_f32 v123, 0, v123
L_noown:
    v_mov_b32 v39, 142980
    s_mov_b32 s33, 2000000
Lsp_183:
    ds_read_b32 v4, v39
    s_waitcnt lgkmcnt(0)
    v_readfirstlane_b32 s32, v4
    s_nop 0
    s_cmp_ge_u32 s32, 4
    s_cbranch_scc1 Lsd_184
    s_sub_u32 s33, s33, 1
    s_cbranch_scc1 Lsd_184
    s_sleep 1
    s_branch Lsp_183
Lsd_184:
    v_mov_b32 v6, v80
    v_mov_b32 v7, v81
    v_mov_b32 v8, v82
    v_mov_b32 v9, v83
    v_lshlrev_b32 v72, 16, v6
    v_and_b32 v73, 0xffff0000, v6
    v_lshlrev_b32 v74, 16, v7
    v_and_b32 v75, 0xffff0000, v7
    v_add_f32 v72, 1.0, v72
    v_add_f32 v73, 1.0, v73
    v_add_f32 v74, 1.0, v74
    v_add_f32 v75, 1.0, v75
    v_cvt_pk_bf16_f32 v6, v72, v73
    v_cvt_pk_bf16_f32 v7, v74, v75
    s_mul_i32 s24, s30, 528
    s_add_u32 s24, s24, 131072
    v_add_u32 v14, s24, v16
    ds_write_b64 v14, v[6:7]
    ds_write_b64 v14, v[8:9] offset:2112
    s_add_u32 s31, s31, 4
    s_waitcnt lgkmcnt(0)
    v_mov_b32 v39, 142976
    v_mov_b32 v4, 1
    s_mov_b64 exec, 1
    ds_add_u32 v39, v4
    s_mov_b64 exec, -1
    v_mov_b32 v39, 142976
    s_mov_b32 s33, 2000000
Lsp_185:
    ds_read_b32 v4, v39
    s_waitcnt lgkmcnt(0)
    v_readfirstlane_b32 s32, v4
    s_nop 0
    s_cmp_ge_u32 s32, s31
    s_cbranch_scc1 Lsd_186
    s_sub_u32 s33, s33, 1
    s_cbranch_scc1 Lsd_186
    s_sleep 1
    s_branch Lsp_185
Lsd_186:
    v_lshrrev_b32 v14, 3, v1
    v_and_b32 v15, 3, v1
    v_lshl_add_u32 v14, v14, 2, v15
    v_mul_u32_u24 v14, 528, v14
    v_lshl_add_u32 v14, v2, 3, v14
    v_add_u32 v14, 131072, v14
    ds_read2_b64 v[40:43], v14 offset0:0 offset1:4
    ds_read2_b64 v[44:47], v14 offset0:8 offset1:12
    ds_read2_b64 v[48:51], v14 offset0:16 offset1:20
    ds_read2_b64 v[52:55], v14 offset0:24 offset1:28
    ds_read2_b64 v[56:59], v14 offset0:32 offset1:36
    ds_read2_b64 v[60:63], v14 offset0:40 offset1:44
    ds_read2_b64 v[64:67], v14 offset0:48 offset1:52
    ds_read2_b64 v[68:71], v14 offset0:56 offset1:60
    s_cmp_lg_u32 s30, 2
    s_cbranch_scc1 L_noml
    s_lshr_b32 s24, s69, 4
    s_lshl_b32 s24, s24, 12
    s_add_u32 s24, s24, 1310720
    v_mov_b32 v39, 142992
    s_mov_b32 s33, 2000000
Lms_187:
    ds_read_b128 v[124:127], v39
    s_waitcnt lgkmcnt(0)
    v_min3_u32 v124, v124, v125, v126
    v_min_u32 v124, v124, v127
    s_nop 0
    v_readfirstlane_b32 s32, v124
    s_nop 0
    s_cmp_ge_u32 s32, 13
    s_cbranch_scc1 Lmd_188
    s_sub_u32 s33, s33, 1
    s_cbranch_scc1 Lmd_188
    s_sleep 2
    s_branch Lms_187
Lmd_188:
    buffer_load_dwordx4 v[72:75], v3, s[12:15], s24 offen offset:0 sc1
    buffer_load_dwordx4 v[76:79], v3, s[12:15], s24 offen offset:1024 sc1
    buffer_load_dwordx4 v[80:83], v3, s[12:15], s24 offen offset:2048 sc1
    buffer_load_dwordx4 v[84:87], v3, s[12:15], s24 offen offset:3072 sc1
    s_mov_b32 s33, 150000
Lpl_189:
    s_waitcnt vmcnt(0)
    v_max3_u32 v4, v72, v74, v76
    v_max3_u32 v4, v4, v78, v80
    v_max3_u32 v4, v4, v82, v84
    v_max_u32 v4, v4, v86
    v_cmp_eq_u32 vcc, -1, v4
    s_cbranch_vccnz Lpl_189_r
Lpd_190:
    s_mov_b32 s24, 0x3fb8aa3b
    v_max3_f32 v6, v72, v76, v80
    v_max_f32 v6, v6, v84
    s_nop 1
    v_max_f32_dpp v6, v6, v6 row_ror:4 row_mask:0xf bank_mask:0xf
    s_nop 1
    v_max_f32_dpp v6, v6, v6 row_ror:8 row_mask:0xf bank_mask:0xf
    v_mov_b32 v10, v6
    s_nop 1
    v_permlane32_swap_b32 v6, v10
    v_max_f32 v6, v6, v10
    v_mov_b32 v10, v6
    s_nop 1
    v_permlane16_swap_b32 v6, v10
    v_max_f32 v6, v6, v10
    v_mov_b32 v7, 0
    v_sub_f32 v10, v72, v6
    v_mul_f32 v10, s24, v10
    v_exp_f32 v10, v10
    s_nop 0
    v_fmac_f32 v7, v10, v73
    v_sub_f32 v10, v76, v6
    v_mul_f32 v10, s24, v10
    v_exp_f32 v10, v10
    s_nop 0
    v_fmac_f32 v7, v10, v77
    v_sub_f32 v10, v80, v6
    v_mul_f32 v10, s24, v10
    v_exp_f32 v10, v10
    s_nop 0
    v_fmac_f32 v7, v10, v81
    v_sub_f32 v10, v84, v6
    v_mul_f32 v10, s24, v10
    v_exp_f32 v10, v10
    s_nop 0
    v_fmac_f32 v7, v10, v85
    s_nop 1
    v_add_f32_dpp v7, v7, v7 row_ror:4 row_mask:0xf bank_mask:0xf
    s_nop 1
    v_add_f32_dpp v7, v7, v7 row_ror:8 row_mask:0xf bank_mask:0xf
    v_mov_b32 v10, v7
    s_nop 1
    v_permlane32_swap_b32 v7, v10
    v_add_f32 v7, v7, v10
    v_mov_b32 v10, v7
    s_nop 1
    v_permlane16_swap_b32 v7, v10
    v_add_f32 v7, v7, v10
    v_rcp_f32 v7, v7
    v_max3_f32 v8, v74, v78, v82
    v_max_f32 v8, v8, v86
    s_nop 1
    v_max_f32_dpp v8, v8, v8 row_ror:4 row_mask:0xf bank_mask:0xf
    s_nop 1
    v_max_f32_dpp v8, v8, v8 row_ror:8 row_mask:0xf bank_mask:0xf
    v_mov_b32 v10, v8
    s_nop 1
    v_permlane32_swap_b32 v8, v10
    v_max_f32 v8, v8, v10
    v_mov_b32 v10, v8
    s_nop 1
    v_permlane16_swap_b32 v8, v10
    v_max_f32 v8, v8, v10
    v_mov_b32 v9, 0
    v_sub_f32 v10, v74, v8
    v_mul_f32 v10, s24, v10
    v_exp_f32 v10, v10
    s_nop 0
    v_fmac_f32 v9, v10, v75
    v_sub_f32 v10, v78, v8
    v_mul_f32 v10, s24, v10
    v_exp_f32 v10, v10
    s_nop 0
    v_fmac_f32 v9, v10, v79
    v_sub_f32 v10, v82, v8
    v_mul_f32 v10, s24, v10
    v_exp_f32 v10, v10
    s_nop 0
    v_fmac_f32 v9, v10, v83
    v_sub_f32 v10, v86, v8
    v_mul_f32 v10, s24, v10
    v_exp_f32 v10, v10
    s_nop 0
    v_fmac_f32 v9, v10, v87
    s_nop 1
    v_add_f32_dpp v9, v9, v9 row_ror:4 row_mask:0xf bank_mask:0xf
    s_nop 1
    v_add_f32_dpp v9, v9, v9 row_ror:8 row_mask:0xf bank_mask:0xf
    v_mov_b32 v10, v9
    s_nop 1
    v_permlane32_swap_b32 v9, v10
    v_add_f32 v9, v9, v10
    v_mov_b32 v10, v9
    s_nop 1
    v_permlane16_swap_b32 v9, v10
    v_add_f32 v9, v9, v10
    v_rcp_f32 v9, v9
    v_add_u32 v14, 143040, v3
    s_mov_b64 exec, 0xf
    ds_write_b128 v14, v[6:9]
    s_mov_b64 exec, -1
    s_waitcnt lgkmcnt(0)
    v_mov_b32 v39, 142984
    v_mov_b32 v4, 1
    s_mov_b64 exec, 1
    ds_add_u32 v39, v4
    s_mov_b64 exec, -1
L_noml:
    s_and_b32 s26, s2, 7
    s_lshr_b32 s28, s2, 3
    s_lshr_b32 s64, s2, 3
    s_add_u32 s65, s64, 2
    s_mul_i32 s65, s65, 43
    s_lshr_b32 s65, s65, 7
    s_add_u32 s65, s65, s64
    s_lshl_b32 s64, s64, 2
    s_sub_u32 s64, s64, 79
    s_min_u32 s64, s64, 27
    s_cmp_lt_u32 s2, 160
    s_cselect_b32 s64, s65, s64
    s_bfe_u32 s65, s2, 131073
    s_bfe_u32 s66, s2, 65536
    v_lshrrev_b32 v14, 2, v1
    v_lshl_add_u32 v14, v2, 2, v14
    s_lshl_b32 s24, s30, 1
    v_and_b32 v6, 3, v1
    v_lshlrev_b32 v6, 3, v6
    v_lshl_add_u32 v6, v14, 8, v6
    s_mov_b32 s25, 7
    v_and_b32 v15, s25, v14
    v_xor_b32 v15, s24, v15
    v_lshl_add_u32 v18, v15, 5, v6
    v_xor_b32 v19, 32, v18
    s_mov_b32 s25, 7
    v_and_b32 v15, s25, v14
    v_xor_b32 v15, s24, v15
    v_lshl_add_u32 v20, v15, 5, v6
    v_add_u32 v20, 65536, v20
    v_xor_b32 v21, 32, v20
    v_lshrrev_b32 v14, 5, v0
    v_add_u32 v14, s24, v14
    v_bfe_u32 v16, v0, 1, 3
    v_xor_b32 v16, v16, v14
    v_lshlrev_b32 v16, 4, v16
    v_lshl_add_u32 v16, v17, 4, v16
    v_add_u32 v23, 98304, v16
    v_lshl_add_u32 v22, v14, 12, v17
    s_lshr_b32 s24, s69, 4
    s_lshl_b32 s24, s24, 15
    s_and_b32 s25, s69, 15
    s_lshl_b32 s25, s25, 8
    s_add_u32 s24, s24, s25
    s_add_u32 s24, s24, 393216
    v_add_u32 v22, s24, v22
    v_lshlrev_b32 v14, 4, v2
    v_lshl_add_u32 v14, v1, 6, v14
    v_add_u32 v28, 131072, v14
    v_cmp_gt_u32 vcc, 4, v1
    v_mov_b32 v24, 536870912
    s_nop 0
    v_cndmask_b32 v24, v24, v14, vcc
    s_lshl_b32 s67, s65, 11
    s_add_u32 s67, s67, 294912
    s_mov_b32 s22, 303104
    v_mul_u32_u24 v16, 320, v2
    v_lshl_add_u32 v16, v1, 4, v16
    s_mul_i32 s24, s30, 1280
    s_add_u32 s24, s24, 133120
    v_add_u32 v25, s24, v16
    v_lshlrev_b32 v14, 2, v2
    v_lshrrev_b32 v16, 2, v1
    v_mul_u32_u24 v16, 320, v16
    v_add_u32 v16, v16, v14
    v_and_b32 v15, 3, v1
    v_lshl_add_u32 v16, v15, 4, v16
    s_lshl_b32 s24, s30, 6
    s_add_u32 s24, s24, 141696
    v_add_u32 v26, s24, v16
    v_mul_u32_u24 v15, 320, v15
    v_lshl_add_u32 v15, v2, 4, v15
    v_add_u32 v27, 133120, v15
    v_lshlrev_b32 v14, 4, v1
    v_lshl_add_u32 v33, v2, 10, v14
    v_lshrrev_b32 v14, 3, v0
    v_and_b32 v15, 7, v0
    v_lshlrev_b32 v15, 4, v15
    v_lshl_add_u32 v32, v14, 8, v15
    s_lshl_b32 s24, s100, 7
    s_add_u32 s24, s24, 294912
    v_lshl_add_u32 v14, v2, 3, v15
    v_add_u32 v29, s24, v14
    s_mul_i32 s27, s100, 16
    s_add_u32 s27, s27, 303104
    v_lshrrev_b32 v14, 1, v0
    v_mul_u32_u24 v14, 16, v14
    v_and_b32 v15, 1, v0
    v_lshl_add_u32 v30, v15, 3, v14
    s_mov_b32 s101, 303616
    v_add_u32 v34, 131072, v3
    s_lshl_b32 s24, s30, 2
    s_add_u32 s24, s24, 143008
    v_mov_b32 v35, s24
    v_mov_b32 v36, 143008
    v_and_b32 v14, 1, v1
    v_lshlrev_b32 v14, 4, v14
    v_mov_b32 v15, 0x3f80
    v_lshlrev_b32 v14, v14, v15
    v_lshrrev_b32 v15, 1, v1
    v_cmp_eq_u32 vcc, 0, v15
    s_nop 1
    v_cndmask_b32 v88, 0, v14, vcc
    v_cmp_eq_u32 vcc, 1, v15
    s_nop 1
    v_cndmask_b32 v92, 0, v14, vcc
    v_cmp_eq_u32 vcc, 0, v15
    s_nop 1
    v_cndmask_b32 v96, 0, v14, vcc
    v_cmp_eq_u32 vcc, 2, v15
    s_nop 1
    v_cndmask_b32 v89, 0, v14, vcc
    v_cmp_eq_u32 vcc, 3, v15
    s_nop 1
    v_cndmask_b32 v93, 0, v14, vcc
    v_cmp_eq_u32 vcc, 1, v15
    s_nop 1
    v_cndmask_b32 v97, 0, v14, vcc
    v_cmp_eq_u32 vcc, 4, v15
    s_nop 1
    v_cndmask_b32 v90, 0, v14, vcc
    v_cmp_eq_u32 vcc, 5, v15
    s_nop 1
    v_cndmask_b32 v94, 0, v14, vcc
    v_cmp_eq_u32 vcc, 2, v15
    s_nop 1
    v_cndmask_b32 v98, 0, v14, vcc
    v_cmp_eq_u32 vcc, 6, v15
    s_nop 1
    v_cndmask_b32 v91, 0, v14, vcc
    v_cmp_eq_u32 vcc, 7, v15
    s_nop 1
    v_cndmask_b32 v95, 0, v14, vcc
    v_cmp_eq_u32 vcc, 3, v15
    s_nop 1
    v_cndmask_b32 v99, 0, v14, vcc
    s_lshr_b32 s24, s100, 1
    s_lshl_b32 s24, s24, 2
    s_add_u32 s24, s24, s30
    s_lshl_b32 s16, s24, 12
    s_add_u32 s16, s16, 393216
    s_and_b32 s34, s24, 31
    s_lshl_b32 s34, s34, 10
    s_lshr_b32 s24, s24, 5
    s_lshl_b32 s24, s24, 8
    s_add_u32 s34, s34, s24
    s_add_u32 s34, s34, 262144
    s_sub_u32 s24, s28, 24
    s_lshl_b32 s24, s24, 2
    s_add_u32 s24, s24, s30
    s_sub_u32 s25, s28, 20
    s_lshl_b32 s25, s25, 1
    s_and_b32 s68, s30, 1
    s_add_u32 s25, s25, s68
    s_cmp_ge_u32 s2, 224
    s_cselect_b32 s96, s24, s25
    s_lshl_b32 s96, s96, 10
    s_add_u32 s96, s96, 262144
    s_lshl_b32 s24, s26, 2
    s_add_u32 s24, s24, s30
    s_lshl_b32 s24, s24, 4
    s_add_u32 s24, s24, s28
    s_sub_u32 s24, s24, 20
    s_lshl_b32 s17, s24, 8
    s_add_u32 s17, s17, 917504
    v_lshlrev_b32 v37, 3, v2
    v_lshl_add_u32 v37, v1, 4, v37
    s_sub_u32 s24, s34, 262144
    s_lshr_b32 s25, s24, 10
    s_mul_i32 s25, s25, 7168
    s_add_u32 s19, s24, s25
    s_add_u32 s19, s19, 1055744
    s_sub_u32 s24, s96, 262144
    s_lshr_b32 s25, s24, 10
    s_lshr_b32 s68, s25, 4
    s_mul_i32 s25, s25, 7168
    s_add_u32 s25, s25, 793600
    v_lshl_add_u32 v14, v2, 1, s68
    v_cmp_eq_u32 vcc, s26, v14
    v_add_u32 v14, s25, v3
    s_nop 0
    v_cndmask_b32 v38, v3, v14, vcc
    s_lshl_b32 s24, s26, 2
    s_add_u32 s24, s24, s30
    s_lshl_b32 s24, s24, 13
    s_lshl_b32 s21, s64, 8
    s_add_u32 s21, s21, s24
    s_add_u32 s21, s21, 1048576
    s_lshr_b32 s24, s100, 1
    s_lshl_b32 s24, s24, 13
    s_and_b32 s25, s100, 1
    s_lshl_b32 s25, s25, 7
    s_add_u32 s24, s24, s25
    s_add_u32 s4, s24, 1048576
    s_add_u32 s5, s24, 1052672
    s_lshr_b32 s24, s100, 1
    s_lshl_b32 s24, s24, 12
    s_add_u32 s18, s24, s25
    s_add_u32 s18, s18, 917504
    s_lshl_b32 s20, s64, 13
    s_lshl_b32 s24, s30, 8
    s_add_u32 s20, s20, s24
    s_add_u32 s20, s20, 0
    s_add_u32 s6, s20, 4096
    s_lshl_b32 s7, s64, 13
    s_lshl_b32 s25, s66, 12
    s_add_u32 s7, s7, s25
    s_lshl_b32 s25, s65, 10
    s_add_u32 s7, s7, s25
    s_add_u32 s7, s7, s24
    s_add_u32 s7, s7, 0
    s_lshl_b32 s97, s26, 7
    s_add_u32 s97, s97, 309248
    s_and_b32 s98, s100, 7
    s_lshl2_add_u32 s98, s98, s97
    v_lshlrev_b32 v14, 3, v0
    v_add_u32 v15, 143232, v14
    v_and_b32 v16, 7, v0
    v_lshlrev_b32 v16, 2, v16
    s_mov_b32 s23, 0xbdd2d3e8
    v_mov_b32 v17, 0xc0135761
    s_mov_b32 s8, s58
    s_mov_b32 s9, s59
    s_mov_b32 s10, 8192
    s_mov_b32 s11, 0x20000
    s_cmp_lg_u32 s30, 3
    s_cbranch_scc1 Lct_195
    s_lshr_b32 s78, s2, 6
    s_and_b32 s79, s2, 63
    s_mul_i32 s79, s79, 15
    s_add_u32 s78, s78, s79
    s_and_b32 s78, s78, 3
    s_mul_i32 s78, s78, 1024
    s_add_u32 s78, s78, 241664
    s_add_u32 s76, s62, s78
    s_addc_u32 s77, s63, 0
    v_mov_b32 v39, 142992
    s_mov_b32 s33, 2000000
Lms_196:
    ds_read_b128 v[124:127], v39
    s_waitcnt lgkmcnt(0)
    v_min3_u32 v124, v124, v125, v126
    v_min_u32 v124, v124, v127
    s_nop 0
    v_readfirstlane_b32 s32, v124
    s_nop 0
    s_cmp_ge_u32 s32, 10
    s_cbranch_scc1 Lmd_197
    s_sub_u32 s33, s33, 1
    s_cbranch_scc1 Lmd_197
    s_sleep 2
    s_branch Lms_196
Lmd_197:
    s_mov_b32 s80, 1
    s_atomic_add s80, s[76:77], 0 glc
    s_waitcnt lgkmcnt(0)
    s_add_u32 s79, s80, 1
    s_cmp_ge_u32 s79, 999
    s_cselect_b32 s80, 2, 0
    s_cmp_ge_u32 s79, 43
    s_cselect_b32 s79, 1, s80
    v_mov_b32 v4, s79
    v_mov_b32 v39, 143024
    ds_write_b32 v39, v4
    s_lshr_b32 s78, s2, 6
    s_and_b32 s79, s2, 63
    s_mul_i32 s79, s79, 20
    s_add_u32 s78, s78, s79
    s_and_b32 s78, s78, 3
    s_mul_i32 s78, s78, 1024
    s_add_u32 s78, s78, 245760
    s_add_u32 s76, s62, s78
    s_addc_u32 s77, s63, 0
    v_mov_b32 v39, 142992
    s_mov_b32 s33, 2000000
Lms_198:
    ds_read_b128 v[124:127], v39
    s_waitcnt lgkmcnt(0)
    v_min3_u32 v124, v124, v125, v126
    v_min_u32 v124, v124, v127
    s_nop 0
    v_readfirstlane_b32 s32, v124
    s_nop 0
    s_cmp_ge_u32 s32, 11
    s_cbranch_scc1 Lmd_199
    s_sub_u32 s33, s33, 1
    s_cbranch_scc1 Lmd_199
    s_sleep 2
    s_branch Lms_198
Lmd_199:
    s_mov_b32 s80, 1
    s_atomic_add s80, s[76:77], 0 glc
    s_waitcnt lgkmcnt(0)
    s_add_u32 s79, s80, 1
    s_cmp_ge_u32 s2, 224
    s_cselect_b32 s80, 36, 0
    s_add_u32 s79, s79, s80
    s_cmp_ge_u32 s79, 999
    s_cselect_b32 s80, 2, 0
    s_cmp_ge_u32 s79, 43
    s_cselect_b32 s79, 1, s80
    v_mov_b32 v4, s79
    v_mov_b32 v39, 143024
    ds_write_b32 v39, v4
    s_lshr_b32 s78, s2, 6
    s_and_b32 s79, s2, 63
    s_mul_i32 s79, s79, 25
    s_add_u32 s78, s78, s79
    s_and_b32 s78, s78, 3
    s_mul_i32 s78, s78, 1024
    s_add_u32 s78, s78, 249856
    s_add_u32 s76, s62, s78
    s_addc_u32 s77, s63, 0
    v_mov_b32 v39, 142992
    s_mov_b32 s33, 2000000
Lms_200:
    ds_read_b128 v[124:127], v39
    s_waitcnt lgkmcnt(0)
    v_min3_u32 v124, v124, v125, v126
    v_min_u32 v124, v124, v127
    s_nop 0
    v_readfirstlane_b32 s32, v124
    s_nop 0
    s_cmp_ge_u32 s32, 12
    s_cbranch_scc1 Lmd_201
    s_sub_u32 s33, s33, 1
    s_cbranch_scc1 Lmd_201
    s_sleep 2
    s_branch Lms_200
Lmd_201:
    s_mov_b32 s80, 1
    s_atomic_add s80, s[76:77], 0 glc
    s_waitcnt lgkmcnt(0)
    s_add_u32 s79, s80, 1
    s_cmp_ge_u32 s2, 224
    s_cselect_b32 s80, 36, 0
    s_add_u32 s79, s79, s80
    s_cmp_ge_u32 s79, 999
    s_cselect_b32 s80, 2, 0
    s_cmp_ge_u32 s79, 43
    s_cselect_b32 s79, 1, s80
    v_mov_b32 v4, s79
    v_mov_b32 v39, 143024
    ds_write_b32 v39, v4
    s_lshr_b32 s78, s2, 6
    s_and_b32 s79, s2, 63
    s_mul_i32 s79, s79, 30
    s_add_u32 s78, s78, s79
    s_and_b32 s78, s78, 3
    s_mul_i32 s78, s78, 1024
    s_add_u32 s78, s78, 253952
    s_add_u32 s76, s62, s78
    s_addc_u32 s77, s63, 0
    v_mov_b32 v39, 142992
    s_mov_b32 s33, 2000000
Lms_202:
    ds_read_b128 v[124:127], v39
    s_waitcnt lgkmcnt(0)
    v_min3_u32 v124, v124, v125, v126
    v_min_u32 v124, v124, v127
    s_nop 0
    v_readfirstlane_b32 s32, v124
    s_nop 0
    s_cmp_ge_u32 s32, 14
    s_cbranch_scc1 Lmd_203
    s_sub_u32 s33, s33, 1
    s_cbranch_scc1 Lmd_203
    s_sleep 2
    s_branch Lms_202
Lmd_203:
    s_mov_b32 s80, 1
    s_atomic_add s80, s[76:77], 0 glc
    s_waitcnt lgkmcnt(0)
    s_add_u32 s79, s80, 1
    s_cmp_ge_u32 s2, 224
    s_cselect_b32 s80, 36, 0
    s_add_u32 s79, s79, s80
    s_cmp_ge_u32 s79, 999
    s_cselect_b32 s80, 2, 0
    s_cmp_ge_u32 s79, 43
    s_cselect_b32 s79, 1, s80
    v_mov_b32 v4, s79
    v_mov_b32 v39, 143024
    ds_write_b32 v39, v4
    s_lshr_b32 s78, s2, 6
    s_and_b32 s79, s2, 63
    s_mul_i32 s79, s79, 35
    s_add_u32 s78, s78, s79
    s_and_b32 s78, s78, 3
    s_mul_i32 s78, s78, 1024
    s_add_u32 s78, s78, 258048
    s_add_u32 s76, s62, s78
    s_addc_u32 s77, s63, 0
    v_mov_b32 v39, 142992
    s_mov_b32 s33, 2000000
Lms_204:
    ds_read_b128 v[124:127], v39
    s_waitcnt lgkmcnt(0)
    v_min3_u32 v124, v124, v125, v126
    v_min_u32 v124, v124, v127
    s_nop 0
    v_readfirstlane_b32 s32, v124
    s_nop 0
    s_cmp_ge_u32 s32, 15
    s_cbranch_scc1 Lmd_205
    s_sub_u32 s33, s33, 1
    s_cbranch_scc1 Lmd_205
    s_sleep 2
    s_branch Lms_204
Lmd_205:
    s_mov_b32 s80, 1
    s_atomic_add s80, s[76:77], 0 glc
    s_waitcnt lgkmcnt(0)
    s_add_u32 s79, s80, 1
    s_cmp_ge_u32 s2, 224
    s_cselect_b32 s80, 36, 0
    s_add_u32 s79, s79, s80
    s_cmp_ge_u32 s79, 999
    s_cselect_b32 s80, 2, 0
    s_cmp_ge_u32 s79, 43
    s_cselect_b32 s79, 1, s80
    v_mov_b32 v4, s79
    v_mov_b32 v39, 143024
    ds_write_b32 v39, v4
Lct_195:
    v_mov_b32 v39, 142984
    s_mov_b32 s33, 2000000
Lsp_206:
    ds_read_b32 v4, v39
    s_waitcnt lgkmcnt(0)
    v_readfirstlane_b32 s32, v4
    s_nop 0
    s_cmp_ge_u32 s32, 1
    s_cbranch_scc1 Lsd_207
    s_sub_u32 s33, s33, 1
    s_cbranch_scc1 Lsd_207
    s_sleep 1
    s_branch Lsp_206
Lsd_207:
    s_lshl_b32 s24, s30, 1
    v_lshrrev_b32 v14, 5, v0
    v_add_u32 v14, s24, v14
    v_lshlrev_b32 v14, 3, v14
    v_add_u32 v15, 143040, v14
    v_lshlrev_b32 v14, 1, v14
    v_add_u32 v14, 143104, v14
    ds_read_b64 v[6:7], v15
    ds_read_b128 v[72:75], v14
    s_mov_b32 s24, 0x3fb8aa3b
    s_waitcnt lgkmcnt(0)
    v_sub_f32 v72, v72, v6
    v_mul_f32 v72, s24, v72
    v_exp_f32 v72, v72
    v_sub_f32 v73, v73, v6
    v_mul_f32 v73, s24, v73
    v_exp_f32 v73, v73
    v_sub_f32 v74, v74, v6
    v_mul_f32 v74, s24, v74
    v_exp_f32 v74, v74
    v_sub_f32 v75, v75, v6
    v_mul_f32 v75, s24, v75
    v_exp_f32 v75, v75
    v_mul_f32 v100, v72, v7
    v_mul_f32 v101, v72, v7
    v_mul_f32 v102, v73, v7
    v_mul_f32 v103, v73, v7
    v_mul_f32 v104, v74, v7
    v_mul_f32 v105, v74, v7
    v_mul_f32 v106, v75, v7
    v_mul_f32 v107, v75, v7
    s_branch L_pad_tail
.p2align 12
L_pad_tail:
    s_setprio 3
    s_barrier
    ds_read_b128 v[72:75], v23 offset:0
    ds_read_b128 v[76:79], v23 offset:8192
    ds_read_b128 v[80:83], v23 offset:16384
    ds_read_b128 v[84:87], v23 offset:24576
    s_waitcnt lgkmcnt(3)
    v_pk_mul_f32 v[72:73], v[72:73], v[100:101]
    v_pk_mul_f32 v[74:75], v[74:75], v[100:101]
    s_waitcnt lgkmcnt(2)
    v_pk_fma_f32 v[72:73], v[76:77], v[102:103], v[72:73]
    v_pk_fma_f32 v[74:75], v[78:79], v[102:103], v[74:75]
    s_waitcnt lgkmcnt(1)
    v_pk_fma_f32 v[72:73], v[80:81], v[104:105], v[72:73]
    v_pk_fma_f32 v[74:75], v[82:83], v[104:105], v[74:75]
    s_waitcnt lgkmcnt(0)
    v_pk_fma_f32 v[72:73], v[84:85], v[106:107], v[72:73]
    v_pk_fma_f32 v[74:75], v[86:87], v[106:107], v[74:75]
    v_cvt_pk_bf16_f32 v6, v72, v73
    v_cvt_pk_bf16_f32 v7, v74, v75
    v_min_u32 v6, -2, v6
    s_cmp_eq_u32 s99, 0
    s_cbranch_scc1 Lls_208_x
    buffer_store_dwordx2 v[6:7], v22, s[12:15], 0 offen
Lls_208:
    v_mov_b32 v4, 1
    ds_write_b32 v35, v4
    s_cmp_lt_u32 s2, 160
    s_cbranch_scc1 L_b2
    s_cmp_ge_u32 s2, 224
    s_cbranch_scc1 L_a1
    s_add_u32 s24, s17, 2048
    s_cmp_lt_u32 s2, 192
    s_cselect_b32 s24, s24, s17
    buffer_load_dword v12, v24, s[12:15], s17 offen sc1
    buffer_load_dword v13, v24, s[12:15], s24 offen sc1
    s_cmp_ge_u32 s30, 2
    s_cbranch_scc1 L_a3
    s_branch L_a2
L_a1:
    buffer_load_dword v12, v38, s[12:15], s96 offen sc1
    buffer_load_dwordx4 v[40:43], v3, s[12:15], s16 offen offset:0 sc1
    buffer_load_dwordx4 v[44:47], v3, s[12:15], s16 offen offset:1024 sc1
    buffer_load_dwordx4 v[48:51], v3, s[12:15], s16 offen offset:2048 sc1
    buffer_load_dwordx4 v[52:55], v3, s[12:15], s16 offen offset:3072 sc1
    s_mov_b32 s33, 150000
Ldp_209:
    buffer_load_dwordx4 v[56:59], v3, s[12:15], s16 offen offset:0 sc1
    buffer_load_dwordx4 v[60:63], v3, s[12:15], s16 offen offset:1024 sc1
    buffer_load_dwordx4 v[64:67], v3, s[12:15], s16 offen offset:2048 sc1
    buffer_load_dwordx4 v[68:71], v3, s[12:15], s16 offen offset:3072 sc1
    s_waitcnt vmcnt(4)
    v_mfma_f32_16x16x32_bf16 v[100:103], v[96:99], v[40:43], 0
    v_mfma_f32_16x16x32_bf16 v[100:103], v[96:99], v[44:47], v[100:103]
    v_mfma_f32_16x16x32_bf16 v[100:103], v[96:99], v[48:51], v[100:103]
    v_mfma_f32_16x16x32_bf16 v[100:103], v[96:99], v[52:55], v[100:103]
    v_max3_u32 v4, v40, v42, v44
    v_max3_u32 v4, v4, v46, v48
    v_max3_u32 v4, v4, v50, v52
    v_max_u32 v4, v4, v54
    v_cmp_eq_u32 vcc, -1, v4
    s_cbranch_vccz Ldp_209_b
    buffer_load_dwordx4 v[40:43], v3, s[12:15], s16 offen offset:0 sc1
    buffer_load_dwordx4 v[44:47], v3, s[12:15], s16 offen offset:1024 sc1
    buffer_load_dwordx4 v[48:51], v3, s[12:15], s16 offen offset:2048 sc1
    buffer_load_dwordx4 v[52:55], v3, s[12:15], s16 offen offset:3072 sc1
    s_sub_u32 s33, s33, 1
    s_cbranch_scc1 Ldp_209_a
    s_waitcnt vmcnt(4)
    v_mfma_f32_16x16x32_bf16 v[100:103], v[96:99], v[56:59], 0
    v_mfma_f32_16x16x32_bf16 v[100:103], v[96:99], v[60:63], v[100:103]
    v_mfma_f32_16x16x32_bf16 v[100:103], v[96:99], v[64:67], v[100:103]
    v_mfma_f32_16x16x32_bf16 v[100:103], v[96:99], v[68:71], v[100:103]
    v_max3_u32 v4, v56, v58, v60
    v_max3_u32 v4, v4, v62, v64
    v_max3_u32 v4, v4, v66, v68
    v_max_u32 v4, v4, v70
    v_cmp_eq_u32 vcc, -1, v4
    s_cbranch_vccnz Ldp_209
Ldp_209_a:
Ldp_209_b:
    s_mov_b32 exec_hi, 0
    s_nop 0
    v_cvt_pk_bf16_f32 v6, v100, v101
    v_cvt_pk_bf16_f32 v7, v102, v103
    v_min_u32 v6, -2, v6
    buffer_store_dwordx2 v[6:7], v37, s[12:15], s34 offen sc1
    s_cmp_eq_u32 s99, 0
    s_cbranch_scc1 Lls_210_x
    buffer_store_dwordx2 v[6:7], v37, s[12:15], s19 offen
Lls_210:
    s_mov_b32 exec_hi, -1
L_a2:
    buffer_load_dwordx4 v[6:9], v38, s[12:15], s96 offen sc1
    s_mov_b32 s33, 150000
Lpl_211:
    s_waitcnt vmcnt(0)
    ds_write_b128 v25, v[6:9]
    v_max_u32 v4, v6, v8
    v_cmp_eq_u32 vcc, -1, v4
    s_cbranch_vccnz Lpl_211_r
Lpd_212:
    s_cmp_ge_u32 s2, 224
    s_cbranch_scc1 L_wo4
L_a3:
    v_mov_b32 v4, 2
    ds_write_b32 v35, v4
    s_mov_b32 s33, 2000000
Lxw_214:
    ds_read_b128 v[124:127], v36
    ds_read_b128 v[128:131], v27 offset:0
    ds_read_b128 v[132:135], v27 offset:64
    s_sub_u32 s33, s33, 1
    s_cbranch_scc1 Lxd_215
    s_waitcnt lgkmcnt(2)
    v_min3_u32 v124, v124, v125, v126
    v_min_u32 v124, v124, v127
    v_cmp_gt_u32 vcc, 2, v124
    s_cbranch_vccnz Lxw_214
Lxd_215:
    ds_read_b128 v[136:139], v27 offset:128
    ds_read_b128 v[140:143], v27 offset:192
    ds_read_b128 v[144:147], v27 offset:1280
    ds_read_b128 v[148:151], v27 offset:1344
    ds_read_b128 v[152:155], v27 offset:1408
    ds_read_b128 v[156:159], v27 offset:1472
    s_waitcnt lgkmcnt(7)
    v_mfma_f32_16x16x32_bf16 v[100:103], v[192:195], v[128:131], 0
    v_mfma_f32_16x16x32_bf16 v[104:107], v[196:199], v[128:131], 0
    s_waitcnt lgkmcnt(6)
    v_mfma_f32_16x16x32_bf16 v[100:103], v[200:203], v[132:135], v[100:103]
    v_mfma_f32_16x16x32_bf16 v[104:107], v[204:207], v[132:135], v[104:107]
    s_waitcnt lgkmcnt(5)
    v_mfma_f32_16x16x32_bf16 v[100:103], v[208:211], v[136:139], v[100:103]
    v_mfma_f32_16x16x32_bf16 v[104:107], v[212:215], v[136:139], v[104:107]
    s_waitcnt lgkmcnt(4)
    v_mfma_f32_16x16x32_bf16 v[100:103], v[216:219], v[140:143], v[100:103]
    v_mfma_f32_16x16x32_bf16 v[104:107], v[220:223], v[140:143], v[104:107]
    s_waitcnt lgkmcnt(3)
    v_mfma_f32_16x16x32_bf16 v[100:103], v[224:227], v[144:147], v[100:103]
    v_mfma_f32_16x16x32_bf16 v[104:107], v[228:231], v[144:147], v[104:107]
    s_waitcnt lgkmcnt(2)
    v_mfma_f32_16x16x32_bf16 v[100:103], v[232:235], v[148:151], v[100:103]
    v_mfma_f32_16x16x32_bf16 v[104:107], v[236:239], v[148:151], v[104:107]
    s_waitcnt lgkmcnt(1)
    v_mfma_f32_16x16x32_bf16 v[100:103], v[240:243], v[152:155], v[100:103]
    v_mfma_f32_16x16x32_bf16 v[104:107], v[244:247], v[152:155], v[104:107]
    s_waitcnt lgkmcnt(0)
    v_mfma_f32_16x16x32_bf16 v[100:103], v[248:251], v[156:159], v[100:103]
    v_mfma_f32_16x16x32_bf16 v[104:107], v[252:255], v[156:159], v[104:107]
    s_cmp_eq_u32 s99, 0
    s_nop 5
    v_cvt_pk_bf16_f32 v100, v100, v101
    v_cvt_pk_bf16_f32 v101, v102, v103
    v_cvt_pk_bf16_f32 v102, v104, v105
    v_cvt_pk_bf16_f32 v103, v106, v107
    v_min_u32 v100, -2, v100
    s_cbranch_scc1 Lls_216_x
    buffer_store_dwordx4 v[100:103], v24, s[12:15], s17 offen
Lls_216:
    v_mov_b32 v4, 3
    ds_write_b32 v35, v4
    s_branch L_b2
Lpl_173_r:
    s_sub_u32 s33, s33, 1
    s_cbranch_scc1 Lpd_174
    s_sleep 16
    v_cmp_eq_u32 vcc, -1, v6
    s_cbranch_vccz Lsk_175
    s_mov_b64 exec, vcc
    buffer_load_dwordx2 v[6:7], v16, s[12:15], s24 offen sc1
    s_mov_b64 exec, -1
Lsk_175:
    v_cmp_eq_u32 vcc, -1, v80
    s_cbranch_vccz Lsk_176
    s_mov_b64 exec, vcc
    buffer_load_dwordx2 v[80:81], v16, s[12:15], s26 offen offset:2048 sc1
    s_mov_b64 exec, -1
Lsk_176:
    v_cmp_eq_u32 vcc, -1, v82
    s_cbranch_vccz Lsk_177
    s_mov_b64 exec, vcc
    buffer_load_dwordx2 v[82:83], v16, s[12:15], s26 offen offset:0 sc1
    s_mov_b64 exec, -1
Lsk_177:
    s_branch Lpl_173
Lpl_178_r:
    s_sub_u32 s33, s33, 1
    s_cbranch_scc1 Lpd_179
    s_sleep 16
    v_cmp_eq_u32 vcc, -1, v72
    s_cbranch_vccz Lsk_180
    s_mov_b64 exec, vcc
    buffer_load_dwordx2 v[72:73], v14, s[12:15], s16 offen sc1
    s_mov_b64 exec, -1
Lsk_180:
    v_cmp_eq_u32 vcc, -1, v74
    s_cbranch_vccz Lsk_181
    s_mov_b64 exec, vcc
    buffer_load_dwordx2 v[74:75], v14, s[12:15], s17 offen sc1
    s_mov_b64 exec, -1
Lsk_181:
    v_cmp_eq_u32 vcc, -1, v76
    s_cbranch_vccz Lsk_182
    s_mov_b64 exec, vcc
    buffer_load_dwordx2 v[76:77], v14, s[12:15], s18 offen sc1
    s_mov_b64 exec, -1
Lsk_182:
    s_branch Lpl_178
Lpl_189_r:
    s_sub_u32 s33, s33, 1
    s_cbranch_scc1 Lpd_190
    s_sleep 16
    v_max_u32 v4, v72, v74
    v_cmp_eq_u32 vcc, -1, v4
    s_cbranch_vccz Lsk_191
    s_mov_b64 exec, vcc
    buffer_load_dwordx4 v[72:75], v3, s[12:15], s24 offen offset:0 sc1
    s_mov_b64 exec, -1
Lsk_191:
    v_max_u32 v4, v76, v78
    v_cmp_eq_u32 vcc, -1, v4
    s_cbranch_vccz Lsk_192
    s_mov_b64 exec, vcc
    buffer_load_dwordx4 v[76:79], v3, s[12:15], s24 offen offset:1024 sc1
    s_mov_b64 exec, -1
Lsk_192:
    v_max_u32 v4, v80, v82
    v_cmp_eq_u32 vcc, -1, v4
    s_cbranch_vccz Lsk_193
    s_mov_b64 exec, vcc
    buffer_load_dwordx4 v[80:83], v3, s[12:15], s24 offen offset:2048 sc1
    s_mov_b64 exec, -1
Lsk_193:
    v_max_u32 v4, v84, v86
    v_cmp_eq_u32 vcc, -1, v4
    s_cbranch_vccz Lsk_194
    s_mov_b64 exec, vcc
    buffer_load_dwordx4 v[84:87], v3, s[12:15], s24 offen offset:3072 sc1
    s_mov_b64 exec, -1
Lsk_194:
    s_branch Lpl_189
Lpl_211_r:
    s_sub_u32 s33, s33, 1
    s_cbranch_scc1 Lpd_212
    v_max_u32 v4, v6, v8
    v_cmp_eq_u32 vcc, -1, v4
    s_cbranch_vccz Lsk_213
    s_mov_b64 exec, vcc
    buffer_load_dwordx4 v[6:9], v38, s[12:15], s96 offen sc1
    s_mov_b64 exec, -1
Lsk_213:
    s_branch Lpl_211
L_wo4:
    s_waitcnt lgkmcnt(0)
    s_barrier
    ds_read_b128 v[40:43], v27 offset:0
    ds_read_b128 v[44:47], v27 offset:64
    ds_read_b128 v[48:51], v27 offset:128
    ds_read_b128 v[52:55], v27 offset:192
    ds_read_b128 v[56:59], v27 offset:1280
    ds_read_b128 v[60:63], v27 offset:1344
    ds_read_b128 v[64:67], v27 offset:1408
    ds_read_b128 v[68:71], v27 offset:1472
    ds_read_b128 v[72:75], v27 offset:2560
    ds_read_b128 v[76:79], v27 offset:2624
    ds_read_b128 v[80:83], v27 offset:2688
    ds_read_b128 v[84:87], v27 offset:2752
    s_waitcnt lgkmcnt(11)
    v_mfma_f32_16x16x32_bf16 v[100:103], v[128:131], v[40:43], 0
    v_mfma_f32_16x16x32_bf16 v[104:107], v[132:135], v[40:43], 0
    ds_read_b128 v[40:43], v27 offset:3840
    s_waitcnt lgkmcnt(11)
    v_mfma_f32_16x16x32_bf16 v[100:103], v[136:139], v[44:47], v[100:103]
    v_mfma_f32_16x16x32_bf16 v[104:107], v[140:143], v[44:47], v[104:107]
    ds_read_b128 v[44:47], v27 offset:3904
    s_waitcnt lgkmcnt(11)
    v_mfma_f32_16x16x32_bf16 v[100:103], v[144:147], v[48:51], v[100:103]
    v_mfma_f32_16x16x32_bf16 v[104:107], v[148:151], v[48:51], v[104:107]
    ds_read_b128 v[48:51], v27 offset:3968
    s_waitcnt lgkmcnt(11)
    v_mfma_f32_16x16x32_bf16 v[100:103], v[152:155], v[52:55], v[100:103]
    v_mfma_f32_16x16x32_bf16 v[104:107], v[156:159], v[52:55], v[104:107]
    ds_read_b128 v[52:55], v27 offset:4032
    s_waitcnt lgkmcnt(11)
    v_mfma_f32_16x16x32_bf16 v[100:103], v[160:163], v[56:59], v[100:103]
    v_mfma_f32_16x16x32_bf16 v[104:107], v[164:167], v[56:59], v[104:107]
    s_waitcnt lgkmcnt(10)
    v_mfma_f32_16x16x32_bf16 v[100:103], v[168:171], v[60:63], v[100:103]
    v_mfma_f32_16x16x32_bf16 v[104:107], v[172:175], v[60:63], v[104:107]
    s_waitcnt lgkmcnt(9)
    v_mfma_f32_16x16x32_bf16 v[100:103], v[176:179], v[64:67], v[100:103]
    v_mfma_f32_16x16x32_bf16 v[104:107], v[180:183], v[64:67], v[104:107]
    s_waitcnt lgkmcnt(8)
    v_mfma_f32_16x16x32_bf16 v[100:103], v[184:187], v[68:71], v[100:103]
    v_mfma_f32_16x16x32_bf16 v[104:107], v[188:191], v[68:71], v[104:107]
    s_waitcnt lgkmcnt(7)
    v_mfma_f32_16x16x32_bf16 v[100:103], v[192:195], v[72:75], v[100:103]
    v_mfma_f32_16x16x32_bf16 v[104:107], v[196:199], v[72:75], v[104:107]
    s_waitcnt lgkmcnt(6)
    v_mfma_f32_16x16x32_bf16 v[100:103], v[200:203], v[76:79], v[100:103]
    v_mfma_f32_16x16x32_bf16 v[104:107], v[204:207], v[76:79], v[104:107]
    s_waitcnt lgkmcnt(5)
    v_mfma_f32_16x16x32_bf16 v[100:103], v[208:211], v[80:83], v[100:103]
    v_mfma_f32_16x16x32_bf16 v[104:107], v[212:215], v[80:83], v[104:107]
    s_waitcnt lgkmcnt(4)
    v_mfma_f32_16x16x32_bf16 v[100:103], v[216:219], v[84:87], v[100:103]
    v_mfma_f32_16x16x32_bf16 v[104:107], v[220:223], v[84:87], v[104:107]
    s_waitcnt lgkmcnt(3)
    v_mfma_f32_16x16x32_bf16 v[100:103], v[224:227], v[40:43], v[100:103]
    v_mfma_f32_16x16x32_bf16 v[104:107], v[228:231], v[40:43], v[104:107]
    s_waitcnt lgkmcnt(2)
    v_mfma_f32_16x16x32_bf16 v[100:103], v[232:235], v[44:47], v[100:103]
    v_mfma_f32_16x16x32_bf16 v[104:107], v[236:239], v[44:47], v[104:107]
    s_waitcnt lgkmcnt(1)
    v_mfma_f32_16x16x32_bf16 v[100:103], v[240:243], v[48:51], v[100:103]
    v_mfma_f32_16x16x32_bf16 v[104:107], v[244:247], v[48:51], v[104:107]
    s_waitcnt lgkmcnt(0)
    v_mfma_f32_16x16x32_bf16 v[100:103], v[248:251], v[52:55], v[100:103]
    v_mfma_f32_16x16x32_bf16 v[104:107], v[252:255], v[52:55], v[104:107]
    s_cmp_eq_u32 s99, 0
    s_nop 5
    v_cvt_pk_bf16_f32 v100, v100, v101
    v_cvt_pk_bf16_f32 v101, v102, v103
    v_cvt_pk_bf16_f32 v102, v104, v105
    v_cvt_pk_bf16_f32 v103, v106, v107
    v_min_u32 v100, -2, v100
    s_cbranch_scc1 Lls_217_x
    buffer_store_dwordx4 v[100:103], v24, s[12:15], s17 offen
Lls_217:
    s_cmp_ge_u32 s35, 2
    s_cbranch_scc1 L_fin
    v_mov_b32 v76, 0
    v_mov_b32 v77, 0
    v_mov_b32 v78, 0
    v_mov_b32 v79, 0
    v_mov_b32 v84, 0
    v_mov_b32 v85, 0
    v_mov_b32 v86, 0
    v_mov_b32 v87, 0
    buffer_load_dwordx4 v[80:83], v32, s[12:15], s18 offen offset:0 sc1
    s_mov_b32 exec_hi, 0
    buffer_load_dwordx4 v[84:87], v32, s[12:15], s18 offen offset:2048 sc1
    s_mov_b64 exec, -1
    s_mov_b32 s33, 150000
Ldp_218:
    buffer_load_dwordx4 v[72:75], v32, s[12:15], s18 offen offset:0 sc1
    s_mov_b32 exec_hi, 0
    buffer_load_dwordx4 v[76:79], v32, s[12:15], s18 offen offset:2048 sc1
    s_mov_b64 exec, -1
    s_waitcnt vmcnt(2)
    v_mfma_f32_16x16x32_bf16 v[100:103], v[96:99], v[80:83], 0
    v_mfma_f32_16x16x32_bf16 v[100:103], v[96:99], v[84:87], v[100:103]
    v_max_u32 v4, v80, v84
    v_cmp_eq_u32 vcc, -1, v4
    s_cbranch_vccz Ldp_218_b
    buffer_load_dwordx4 v[80:83], v32, s[12:15], s18 offen offset:0 sc1
    s_mov_b32 exec_hi, 0
    buffer_load_dwordx4 v[84:87], v32, s[12:15], s18 offen offset:2048 sc1
    s_mov_b64 exec, -1
    s_sub_u32 s33, s33, 1
    s_cbranch_scc1 Ldp_218_a
    s_waitcnt vmcnt(2)
    v_mfma_f32_16x16x32_bf16 v[100:103], v[96:99], v[72:75], 0
    v_mfma_f32_16x16x32_bf16 v[100:103], v[96:99], v[76:79], v[100:103]
    v_max_u32 v4, v72, v76
    v_cmp_eq_u32 vcc, -1, v4
    s_cbranch_vccnz Ldp_218
Ldp_218_a:
Ldp_218_b:
    s_nop 4
    v_add_f32_dpp v100, v100, v100 row_ror:8 row_mask:0xf bank_mask:0xf
    v_add_f32_dpp v101, v101, v101 row_ror:8 row_mask:0xf bank_mask:0xf
    v_add_f32_dpp v102, v102, v102 row_ror:8 row_mask:0xf bank_mask:0xf
    v_add_f32_dpp v103, v103, v103 row_ror:8 row_mask:0xf bank_mask:0xf
    v_pk_fma_f32 v[108:109], v[112:113], v[100:101], v[108:109]
    v_pk_fma_f32 v[110:111], v[114:115], v[102:103], v[110:111]
    v_pk_mul_f32 v[100:101], v[108:109], v[120:121]
    v_pk_mul_f32 v[102:103], v[110:111], v[122:123]
    v_cvt_pk_bf16_f32 v6, v100, v101
    v_cvt_pk_bf16_f32 v7, v102, v103
    v_min_u32 v6, -2, v6
    s_mov_b64 exec, 0x00ff00ff
    buffer_store_dwordx2 v[6:7], v29, s[12:15], 0 offen sc1
    s_mov_b64 exec, -1
    s_mov_b64 exec, 1
    s_cmp_eq_u32 s99, 0
    s_cbranch_scc1 Lls_219_x
    buffer_store_dword v0, off, s[12:15], s98
Lls_219:
    s_mov_b64 exec, -1
    v_add_f32 v8, v108, v109
    v_mul_f32 v9, v108, v108
    v_add_f32 v8, v8, v110
    v_fmac_f32 v9, v109, v109
    v_add_f32 v8, v8, v111
    v_fmac_f32 v9, v110, v110
    v_fmac_f32 v9, v111, v111
    s_nop 1
    v_permlane16_swap_b32 v8, v9
    v_add_f32 v8, v8, v9
    s_nop 1
    v_add_f32_dpp v8, v8, v8 quad_perm:[1,0,3,2] row_mask:0xf bank_mask:0xf
    s_nop 1
    v_add_f32_dpp v8, v8, v8 quad_perm:[2,3,0,1] row_mask:0xf bank_mask:0xf
    s_nop 1
    v_mov_b32_dpp v10, v8 row_shl:4 row_mask:0xf bank_mask:0xf
    v_min_u32 v8, -2, v8
    v_min_u32 v10, -2, v10
    s_nop 0
    v_permlane16_swap_b32 v8, v9
    v_permlane16_swap_b32 v10, v11
    s_mov_b64 exec, 1
    buffer_store_dwordx4 v[8:11], off, s[12:15], s27 sc1
    s_mov_b64 exec, -1
    v_mov_b32 v52, 0
    v_mov_b32 v53, 0
    v_mov_b32 v54, 0
    v_mov_b32 v55, 0
    v_mov_b32 v68, 0
    v_mov_b32 v69, 0
    v_mov_b32 v70, 0
    v_mov_b32 v71, 0
    buffer_load_dwordx4 v[56:59], v32, s[12:15], s4 offen offset:0 sc1
    buffer_load_dwordx4 v[60:63], v32, s[12:15], s4 offen offset:2048 sc1
    buffer_load_dwordx4 v[64:67], v32, s[12:15], s5 offen offset:0 sc1
    s_mov_b32 exec_hi, 0
    buffer_load_dwordx4 v[68:71], v32, s[12:15], s5 offen offset:2048 sc1
    s_mov_b64 exec, -1
    s_mov_b32 s33, 150000
Ldp_220:
    buffer_load_dwordx4 v[40:43], v32, s[12:15], s4 offen offset:0 sc1
    buffer_load_dwordx4 v[44:47], v32, s[12:15], s4 offen offset:2048 sc1
    buffer_load_dwordx4 v[48:51], v32, s[12:15], s5 offen offset:0 sc1
    s_mov_b32 exec_hi, 0
    buffer_load_dwordx4 v[52:55], v32, s[12:15], s5 offen offset:2048 sc1
    s_mov_b64 exec, -1
    s_waitcnt vmcnt(4)
    v_mfma_f32_16x16x32_bf16 v[100:103], v[96:99], v[56:59], 0
    v_mfma_f32_16x16x32_bf16 v[100:103], v[96:99], v[60:63], v[100:103]
    v_mfma_f32_16x16x32_bf16 v[100:103], v[96:99], v[64:67], v[100:103]
    v_mfma_f32_16x16x32_bf16 v[100:103], v[96:99], v[68:71], v[100:103]
    v_max3_u32 v4, v56, v60, v64
    v_max_u32 v4, v4, v68
    v_cmp_eq_u32 vcc, -1, v4
    s_cbranch_vccz Ldp_220_b
    buffer_load_dwordx4 v[56:59], v32, s[12:15], s4 offen offset:0 sc1
    buffer_load_dwordx4 v[60:63], v32, s[12:15], s4 offen offset:2048 sc1
    buffer_load_dwordx4 v[64:67], v32, s[12:15], s5 offen offset:0 sc1
    s_mov_b32 exec_hi, 0
    buffer_load_dwordx4 v[68:71], v32, s[12:15], s5 offen offset:2048 sc1
    s_mov_b64 exec, -1
    s_sub_u32 s33, s33, 1
    s_cbranch_scc1 Ldp_220_a
    s_waitcnt vmcnt(4)
    v_mfma_f32_16x16x32_bf16 v[100:103], v[96:99], v[40:43], 0
    v_mfma_f32_16x16x32_bf16 v[100:103], v[96:99], v[44:47], v[100:103]
    v_mfma_f32_16x16x32_bf16 v[100:103], v[96:99], v[48:51], v[100:103]
    v_mfma_f32_16x16x32_bf16 v[100:103], v[96:99], v[52:55], v[100:103]
    v_max3_u32 v4, v40, v44, v48
    v_max_u32 v4, v4, v52
    v_cmp_eq_u32 vcc, -1, v4
    s_cbranch_vccnz Ldp_220
Ldp_220_a:
Ldp_220_b:
    s_nop 3
    v_add_f32_dpp v100, v100, v100 row_ror:8 row_mask:0xf bank_mask:0xf
    v_add_f32_dpp v101, v101, v101 row_ror:8 row_mask:0xf bank_mask:0xf
    v_add_f32_dpp v102, v102, v102 row_ror:8 row_mask:0xf bank_mask:0xf
    v_add_f32_dpp v103, v103, v103 row_ror:8 row_mask:0xf bank_mask:0xf
    v_pk_fma_f32 v[108:109], v[116:117], v[100:101], v[108:109]
    v_pk_fma_f32 v[110:111], v[118:119], v[102:103], v[110:111]
    v_cvt_pk_bf16_f32 v6, v108, v109
    v_cvt_pk_bf16_f32 v7, v110, v111
    s_mov_b64 exec, 0x00ff00ff
    buffer_store_dwordx2 v[6:7], v31, s[8:11], 0 offen
    s_endpgm
.p2align 12
L_b2:
    s_waitcnt vmcnt(0)
    v_mov_b32 v39, 142992
    s_mov_b32 s33, 2000000
Lms_221:
    ds_read_b128 v[124:127], v39
    s_waitcnt lgkmcnt(0)
    v_min3_u32 v124, v124, v125, v126
    v_min_u32 v124, v124, v127
    s_nop 0
    v_readfirstlane_b32 s32, v124
    s_nop 0
    s_cmp_ge_u32 s32, 16
    s_cbranch_scc1 Lmd_222
    s_sub_u32 s33, s33, 1
    s_cbranch_scc1 Lmd_222
    s_sleep 1
    s_branch Lms_221
Lmd_222:
    ds_read_b64_tr_b16 v[128:129], v18 offset:0
    ds_read_b64_tr_b16 v[132:133], v19 offset:0
    ds_read_b64_tr_b16 v[130:131], v18 offset:4096
    ds_read_b64_tr_b16 v[134:135], v19 offset:4096
    ds_read_b64_tr_b16 v[136:137], v18 offset:8192
    ds_read_b64_tr_b16 v[140:141], v19 offset:8192
    ds_read_b64_tr_b16 v[138:139], v18 offset:12288
    ds_read_b64_tr_b16 v[142:143], v19 offset:12288
    s_waitcnt lgkmcnt(4)
    ds_read_b64_tr_b16 v[144:145], v18 offset:16384
    ds_read_b64_tr_b16 v[148:149], v19 offset:16384
    ds_read_b64_tr_b16 v[146:147], v18 offset:20480
    ds_read_b64_tr_b16 v[150:151], v19 offset:20480
    ds_read_b64_tr_b16 v[152:153], v18 offset:24576
    ds_read_b64_tr_b16 v[156:157], v19 offset:24576
    ds_read_b64_tr_b16 v[154:155], v18 offset:28672
    ds_read_b64_tr_b16 v[158:159], v19 offset:28672
    s_waitcnt lgkmcnt(4)
    ds_read_b64_tr_b16 v[160:161], v18 offset:32768
    ds_read_b64_tr_b16 v[164:165], v19 offset:32768
    ds_read_b64_tr_b16 v[162:163], v18 offset:36864
    ds_read_b64_tr_b16 v[166:167], v19 offset:36864
    ds_read_b64_tr_b16 v[168:169], v18 offset:40960
    ds_read_b64_tr_b16 v[172:173], v19 offset:40960
    ds_read_b64_tr_b16 v[170:171], v18 offset:45056
    ds_read_b64_tr_b16 v[174:175], v19 offset:45056
    s_waitcnt lgkmcnt(4)
    ds_read_b64_tr_b16 v[176:177], v18 offset:49152
    ds_read_b64_tr_b16 v[180:181], v19 offset:49152
    ds_read_b64_tr_b16 v[178:179], v18 offset:53248
    ds_read_b64_tr_b16 v[182:183], v19 offset:53248
    ds_read_b64_tr_b16 v[184:185], v18 offset:57344
    ds_read_b64_tr_b16 v[188:189], v19 offset:57344
    ds_read_b64_tr_b16 v[186:187], v18 offset:61440
    ds_read_b64_tr_b16 v[190:191], v19 offset:61440
    s_waitcnt lgkmcnt(4)
    s_cmp_lg_u32 s30, 0
    s_cbranch_scc1 L_b3
    buffer_load_dword v80, v16, s[12:15], s97 offen sc1
    s_mov_b32 s33, 150000
Lpl_223:
    s_waitcnt vmcnt(0)
    v_cmp_eq_u32 vcc, -1, v80
    s_cbranch_vccnz Lpl_223_r
Lpd_224:
    buffer_load_dwordx4 v[72:75], v3, s[12:15], s67 offen offset:0 sc1
    buffer_load_dwordx4 v[76:79], v3, s[12:15], s67 offen offset:1024 sc1
    s_waitcnt lgkmcnt(0)
    s_mov_b32 s33, 150000
Lpl_226:
    s_waitcnt vmcnt(0)
    ds_write_b128 v34, v[72:75] offset:0
    ds_write_b128 v34, v[76:79] offset:1024
    v_max3_u32 v4, v72, v74, v76
    v_max_u32 v4, v4, v78
    v_cmp_eq_u32 vcc, -1, v4
    s_cbranch_vccnz Lpl_226_r
Lpd_227:
    v_mov_b32 v4, 4
    ds_write_b32 v35, v4
L_b3:
    s_mov_b32 s33, 2000000
    s_mov_b32 exec_lo, 0x000f000f
    s_mov_b32 exec_hi, 0x000f000f
Lxw_230:
    ds_read_b32 v124, v36
    ds_read_b128 v[40:43], v28 offset:0
    ds_read_b128 v[44:47], v28 offset:256
    s_sub_u32 s33, s33, 1
    s_cbranch_scc1 Lxd_231
    s_waitcnt lgkmcnt(2)
    v_cmp_gt_u32 vcc, 4, v124
    s_cbranch_vccnz Lxw_230
Lxd_231:
    ds_read_b128 v[48:51], v28 offset:512
    ds_read_b128 v[52:55], v28 offset:768
    ds_read_b128 v[56:59], v28 offset:1024
    ds_read_b128 v[60:63], v28 offset:1280
    ds_read_b128 v[64:67], v28 offset:1536
    ds_read_b128 v[68:71], v28 offset:1792
    s_mov_b64 exec, -1
    buffer_load_dwordx2 v[72:73], v30, s[12:15], s22 offen sc1
    buffer_load_dwordx2 v[74:75], v30, s[12:15], s101 offen sc1
    s_waitcnt lgkmcnt(7)
    v_mfma_f32_16x16x32_bf16 v[100:103], v[128:131], v[40:43], 0
    v_mfma_f32_16x16x32_bf16 v[104:107], v[132:135], v[40:43], 0
    s_waitcnt lgkmcnt(6)
    v_mfma_f32_16x16x32_bf16 v[100:103], v[136:139], v[44:47], v[100:103]
    v_mfma_f32_16x16x32_bf16 v[104:107], v[140:143], v[44:47], v[104:107]
    s_waitcnt lgkmcnt(5)
    v_mfma_f32_16x16x32_bf16 v[100:103], v[144:147], v[48:51], v[100:103]
    v_mfma_f32_16x16x32_bf16 v[104:107], v[148:151], v[48:51], v[104:107]
    s_waitcnt lgkmcnt(4)
    v_mfma_f32_16x16x32_bf16 v[100:103], v[152:155], v[52:55], v[100:103]
    v_mfma_f32_16x16x32_bf16 v[104:107], v[156:159], v[52:55], v[104:107]
    s_waitcnt lgkmcnt(3)
    v_mfma_f32_16x16x32_bf16 v[100:103], v[160:163], v[56:59], v[100:103]
    v_mfma_f32_16x16x32_bf16 v[104:107], v[164:167], v[56:59], v[104:107]
    s_waitcnt lgkmcnt(2)
    v_mfma_f32_16x16x32_bf16 v[100:103], v[168:171], v[60:63], v[100:103]
    v_mfma_f32_16x16x32_bf16 v[104:107], v[172:175], v[60:63], v[104:107]
    s_waitcnt lgkmcnt(1)
    v_mfma_f32_16x16x32_bf16 v[100:103], v[176:179], v[64:67], v[100:103]
    v_mfma_f32_16x16x32_bf16 v[104:107], v[180:183], v[64:67], v[104:107]
    s_waitcnt lgkmcnt(0)
    v_mfma_f32_16x16x32_bf16 v[100:103], v[184:187], v[68:71], v[100:103]
    v_mfma_f32_16x16x32_bf16 v[104:107], v[188:191], v[68:71], v[104:107]
    s_nop 6
    v_mov_b32_dpp v80, v100 row_shl:8 row_mask:0xf bank_mask:0xf
    v_mov_b32_dpp v81, v101 row_shl:8 row_mask:0xf bank_mask:0xf
    v_mov_b32_dpp v82, v102 row_shl:8 row_mask:0xf bank_mask:0xf
    v_mov_b32_dpp v83, v103 row_shl:8 row_mask:0xf bank_mask:0xf
    v_mov_b32_dpp v84, v104 row_shl:8 row_mask:0xf bank_mask:0xf
    v_mov_b32_dpp v85, v105 row_shl:8 row_mask:0xf bank_mask:0xf
    v_mov_b32_dpp v86, v106 row_shl:8 row_mask:0xf bank_mask:0xf
    v_mov_b32_dpp v87, v107 row_shl:8 row_mask:0xf bank_mask:0xf
    s_mov_b32 s33, 150000
Lpl_232:
    s_waitcnt vmcnt(0)
    v_max_u32 v4, v72, v74
    v_cmp_eq_u32 vcc, -1, v4
    s_cbranch_vccnz Lpl_232_r
Lpd_233:
    v_pk_add_f32 v[72:73], v[72:73], v[74:75]
    s_nop 1
    v_permlane32_swap_b32 v72, v73
    v_add_f32 v72, v72, v73
    s_nop 1
    v_add_f32_dpp v72, v72, v72 row_ror:4 row_mask:0xf bank_mask:0xf
    s_nop 1
    v_add_f32_dpp v72, v72, v72 row_ror:8 row_mask:0xf bank_mask:0xf
    v_mov_b32 v73, v72
    s_nop 1
    v_permlane16_swap_b32 v72, v73
    v_add_f32 v72, v72, v73
    v_mov_b32 v73, v72
    s_nop 1
    v_permlane32_swap_b32 v72, v73
    v_mul_f32 v72, 0xba800000, v72
    v_mul_f32 v73, 0x3a800000, v73
    v_fma_f32 v73, -v72, v72, v73
    v_cvt_pk_bf16_f32 v74, 0, v72
    v_max_f32 v73, 0, v73
    s_nop 0
    v_fmac_f32_dpp v100, v100, v74 row_shl:4 row_mask:0xf bank_mask:0xf
    v_cvt_pk_bf16_f32 v73, 0, v73
    v_fmac_f32_dpp v101, v101, v74 row_shl:4 row_mask:0xf bank_mask:0xf
    v_add_f32 v73, 0x3727c5ac, v73
    v_fmac_f32_dpp v102, v102, v74 row_shl:4 row_mask:0xf bank_mask:0xf
    v_cvt_pk_bf16_f32 v73, 0, v73
    v_fmac_f32_dpp v103, v103, v74 row_shl:4 row_mask:0xf bank_mask:0xf
    v_sqrt_f32 v73, v73
    v_fmac_f32_dpp v104, v104, v74 row_shl:4 row_mask:0xf bank_mask:0xf
    v_cvt_pk_bf16_f32 v73, 0, v73
    v_fmac_f32_dpp v105, v105, v74 row_shl:4 row_mask:0xf bank_mask:0xf
    v_rcp_f32 v73, v73
    v_fmac_f32_dpp v106, v106, v74 row_shl:4 row_mask:0xf bank_mask:0xf
    v_fmac_f32_dpp v107, v107, v74 row_shl:4 row_mask:0xf bank_mask:0xf
    v_pk_fma_f32 v[80:81], v[100:101], v[72:73], v[80:81] op_sel:[0,1,0] op_sel_hi:[1,1,1]
    v_pk_fma_f32 v[82:83], v[102:103], v[72:73], v[82:83] op_sel:[0,1,0] op_sel_hi:[1,1,1]
    v_pk_fma_f32 v[84:85], v[104:105], v[72:73], v[84:85] op_sel:[0,1,0] op_sel_hi:[1,1,1]
    v_pk_fma_f32 v[86:87], v[106:107], v[72:73], v[86:87] op_sel:[0,1,0] op_sel_hi:[1,1,1]
    v_cvt_pk_bf16_f32 v80, v80, v81
    v_cvt_pk_bf16_f32 v81, v82, v83
    v_cvt_pk_bf16_f32 v82, v84, v85
    v_cvt_pk_bf16_f32 v83, v86, v87
    v_min_u32 v80, -2, v80
    buffer_store_dwordx4 v[80:83], v24, s[12:15], s7 offen sc1
    v_mov_b32 v39, 142992
    s_mov_b32 s33, 2000000
Lms_236:
    ds_read_b128 v[124:127], v39
    s_waitcnt lgkmcnt(0)
    v_min3_u32 v124, v124, v125, v126
    v_min_u32 v124, v124, v127
    s_nop 0
    v_readfirstlane_b32 s32, v124
    s_nop 0
    s_cmp_ge_u32 s32, 17
    s_cbranch_scc1 Lmd_237
    s_sub_u32 s33, s33, 1
    s_cbranch_scc1 Lmd_237
    s_sleep 1
    s_branch Lms_236
Lmd_237:
    ds_read_b64_tr_b16 v[192:193], v20 offset:0
    ds_read_b64_tr_b16 v[196:197], v21 offset:0
    ds_read_b64_tr_b16 v[194:195], v20 offset:4096
    ds_read_b64_tr_b16 v[198:199], v21 offset:4096
    ds_read_b64_tr_b16 v[200:201], v20 offset:8192
    ds_read_b64_tr_b16 v[204:205], v21 offset:8192
    ds_read_b64_tr_b16 v[202:203], v20 offset:12288
    ds_read_b64_tr_b16 v[206:207], v21 offset:12288
    s_waitcnt lgkmcnt(4)
    ds_read_b64_tr_b16 v[208:209], v20 offset:16384
    ds_read_b64_tr_b16 v[212:213], v21 offset:16384
    ds_read_b64_tr_b16 v[210:211], v20 offset:20480
    ds_read_b64_tr_b16 v[214:215], v21 offset:20480
    ds_read_b64_tr_b16 v[216:217], v20 offset:24576
    ds_read_b64_tr_b16 v[220:221], v21 offset:24576
    ds_read_b64_tr_b16 v[218:219], v20 offset:28672
    ds_read_b64_tr_b16 v[222:223], v21 offset:28672
    s_waitcnt lgkmcnt(4)
    s_waitcnt vmcnt(0)
    buffer_load_dwordx4 v[72:75], v33, s[12:15], s20 offen sc1
    buffer_load_dwordx4 v[76:79], v33, s[12:15], s6 offen sc1
    s_mov_b32 s33, 150000
Lpl_238:
    s_waitcnt vmcnt(0)
    v_mfma_f32_16x16x32_bf16 v[100:103], v[88:91], v[72:75], 0
    v_mfma_f32_16x16x32_bf16 v[100:103], v[92:95], v[76:79], v[100:103]
    v_max_u32 v4, v72, v76
    v_cmp_eq_u32 vcc, -1, v4
    s_cbranch_vccnz Lpl_238_r
Lpd_239:
    s_nop 4
    v_pk_mul_f32 v[6:7], v[100:101], v[100:101]
    v_fma_f32 v6, v6, s23, v17
    v_fma_f32 v7, v7, s23, v17
    v_pk_mul_f32 v[6:7], v[6:7], v[100:101]
    v_exp_f32 v6, v6
    v_exp_f32 v7, v7
    v_add_f32 v6, 1.0, v6
    v_add_f32 v7, 1.0, v7
    v_rcp_f32 v6, v6
    v_rcp_f32 v7, v7
    v_mul_f32 v6, v6, v100
    v_mul_f32 v7, v7, v101
    v_pk_mul_f32 v[6:7], v[6:7], v[102:103]
    v_cvt_pk_bf16_f32 v6, v6, v7
    ds_write_b32 v26, v6
    s_waitcnt lgkmcnt(0)
    s_barrier
    ds_read_b128 v[72:75], v27 offset:8576
    ds_read_b128 v[76:79], v27 offset:8640
    ds_read_b128 v[80:83], v27 offset:8704
    ds_read_b128 v[84:87], v27 offset:8768
    s_waitcnt lgkmcnt(3)
    v_mfma_f32_16x16x32_bf16 v[100:103], v[192:195], v[72:75], 0
    v_mfma_f32_16x16x32_bf16 v[104:107], v[196:199], v[72:75], 0
    s_waitcnt lgkmcnt(2)
    v_mfma_f32_16x16x32_bf16 v[100:103], v[200:203], v[76:79], v[100:103]
    v_mfma_f32_16x16x32_bf16 v[104:107], v[204:207], v[76:79], v[104:107]
    s_waitcnt lgkmcnt(1)
    v_mfma_f32_16x16x32_bf16 v[100:103], v[208:211], v[80:83], v[100:103]
    v_mfma_f32_16x16x32_bf16 v[104:107], v[212:215], v[80:83], v[104:107]
    s_waitcnt lgkmcnt(0)
    v_mfma_f32_16x16x32_bf16 v[100:103], v[216:219], v[84:87], v[100:103]
    v_mfma_f32_16x16x32_bf16 v[104:107], v[220:223], v[84:87], v[104:107]
    s_cmp_eq_u32 s99, 0
    s_nop 5
    v_cvt_pk_bf16_f32 v100, v100, v101
    v_cvt_pk_bf16_f32 v101, v102, v103
    v_cvt_pk_bf16_f32 v102, v104, v105
    v_cvt_pk_bf16_f32 v103, v106, v107
    v_min_u32 v100, -2, v100
    s_cbranch_scc1 Lls_242_x
    buffer_store_dwordx4 v[100:103], v24, s[12:15], s21 offen
Lls_242:
L_fin:
L_end:
    s_endpgm
Lpl_223_r:
    s_sub_u32 s33, s33, 1
    s_cbranch_scc1 Lpd_224
    v_cmp_eq_u32 vcc, -1, v80
    s_cbranch_vccz Lsk_225
    s_mov_b64 exec, vcc
    buffer_load_dword v80, v16, s[12:15], s97 offen sc1
    s_mov_b64 exec, -1
Lsk_225:
    s_branch Lpl_223
Lpl_226_r:
    s_sub_u32 s33, s33, 1
    s_cbranch_scc1 Lpd_227
    v_max_u32 v4, v72, v74
    v_cmp_eq_u32 vcc, -1, v4
    s_cbranch_vccz Lsk_228
    s_mov_b64 exec, vcc
    buffer_load_dwordx4 v[72:75], v3, s[12:15], s67 offen offset:0 sc1
    s_mov_b64 exec, -1
Lsk_228:
    v_max_u32 v4, v76, v78
    v_cmp_eq_u32 vcc, -1, v4
    s_cbranch_vccz Lsk_229
    s_mov_b64 exec, vcc
    buffer_load_dwordx4 v[76:79], v3, s[12:15], s67 offen offset:1024 sc1
    s_mov_b64 exec, -1
Lsk_229:
    s_branch Lpl_226
Lpl_232_r:
    s_sub_u32 s33, s33, 1
    s_cbranch_scc1 Lpd_233
    v_cmp_eq_u32 vcc, -1, v72
    s_cbranch_vccz Lsk_234
    s_mov_b64 exec, vcc
    buffer_load_dwordx2 v[72:73], v30, s[12:15], s22 offen sc1
    s_mov_b64 exec, -1
Lsk_234:
    v_cmp_eq_u32 vcc, -1, v74
    s_cbranch_vccz Lsk_235
    s_mov_b64 exec, vcc
    buffer_load_dwordx2 v[74:75], v30, s[12:15], s101 offen sc1
    s_mov_b64 exec, -1
Lsk_235:
    s_branch Lpl_232
Lpl_238_r:
    s_sub_u32 s33, s33, 1
    s_cbranch_scc1 Lpd_239
    v_cmp_eq_u32 vcc, -1, v72
    s_cbranch_vccz Lsk_240
    s_mov_b64 exec, vcc
    buffer_load_dwordx4 v[72:75], v33, s[12:15], s20 offen sc1
    s_mov_b64 exec, -1
Lsk_240:
    v_cmp_eq_u32 vcc, -1, v76
    s_cbranch_vccz Lsk_241
    s_mov_b64 exec, vcc
    buffer_load_dwordx4 v[76:79], v33, s[12:15], s6 offen sc1
    s_mov_b64 exec, -1
Lsk_241:
    s_branch Lpl_238
Lls_208_x:
    buffer_store_dwordx2 v[6:7], v22, s[12:15], 0 offen sc1
    s_branch Lls_208
Lls_210_x:
    buffer_store_dwordx2 v[6:7], v37, s[12:15], s19 offen sc1
    s_branch Lls_210
Lls_216_x:
    buffer_store_dwordx4 v[100:103], v24, s[12:15], s17 offen sc1
    s_branch Lls_216
Lls_217_x:
    buffer_store_dwordx4 v[100:103], v24, s[12:15], s17 offen sc1
    s_branch Lls_217
Lls_219_x:
    buffer_store_dword v0, off, s[12:15], s98 sc1
    s_branch Lls_219
Lls_242_x:
    buffer_store_dwordx4 v[100:103], v24, s[12:15], s21 offen sc1
    s_branch Lls_242
.section .rodata,"a"
.p2align 6
.amdhsa_kernel adaLN_cond__gqa_block_cached__geglu_ffn__decode_kernel
  .amdhsa_next_free_vgpr 256
  .amdhsa_next_free_sgpr 102
  .amdhsa_accum_offset 256
  .amdhsa_group_segment_fixed_size 0
  .amdhsa_kernarg_size 112
  .amdhsa_user_sgpr_count 2
  .amdhsa_user_sgpr_kernarg_segment_ptr 1
  .amdhsa_system_sgpr_workgroup_id_x 1
  .amdhsa_float_denorm_mode_32 3
.end_amdhsa_kernel
```
